```python
import torch

def _softmax(x, axis=-1):
    return torch.softmax(x, dim=axis)
def _gelu(x):
    return torch.nn.functional.gelu(x, approximate="tanh")
def _silu(x):
    return torch.nn.functional.silu(x)
def _sigmoid(x):
    return torch.sigmoid(x)
def _layernorm(x, axis=-1, eps=1e-5):
    m = x.mean(dim=axis, keepdim=True)
    v = x.var(dim=axis, keepdim=True, unbiased=False)
    return (x - m) / torch.sqrt(v + eps)
def _scatter_add(tgt, idx, src, axis=0):
    return tgt.clone().index_add_(axis, idx, src)
def _segment_sum(src, seg, n):
    out = torch.zeros((n,) + src.shape[1:], dtype=src.dtype)
    return out.index_add_(0, seg, src)
def _pad(x, pw):
    flat = tuple(v for pair in reversed(pw) for v in pair)
    return torch.nn.functional.pad(x, flat)

kernel_name = 'standalone__gqa_block_cached__near_ridge'

def setup_inputs():

    _w = (lambda a: (lambda t: t.to(torch.bfloat16) if t.is_floating_point() else t)(torch.as_tensor(a)))
    B, Sq, D = 32, 32, 512
    Hq, Hkv, Sk, Dh = 32, 8, 512, 128
    assert Hq % Hkv == 0, (Hq, Hkv)
    return {
        "x": _w((lambda *s: torch.randn(*s, dtype=torch.bfloat16) * 0.8)(B, Sq, D)),
        "k_cache": _w((lambda *s: torch.randn(*s, dtype=torch.bfloat16) * 0.8)(B, Hkv, Sk, Dh)),
        "v_cache": _w((lambda *s: torch.randn(*s, dtype=torch.bfloat16) * 0.05)(B, Hkv, Sk, Dh)),
        "wq": _w((lambda *s: torch.randn(*s, dtype=torch.bfloat16) * 0.8)(D, Hq * Dh) * (D ** -0.5)),
        "wo": _w((lambda *s: torch.randn(*s, dtype=torch.bfloat16) * 0.05)(Hq * Dh, D) * ((Hq * Dh) ** -0.5)),
    }

def reference(x, k_cache, v_cache, wq, wo):
    B, Sq, D = x.shape
    Hq, Dh = 32, 128
    Hkv = k_cache.shape[1]
    rep = Hq // Hkv
    q = (lambda x, *d: x.permute(*d))((x @ wq).reshape(B, Sq, Hq, Dh), 0, 2, 1, 3)
    k = (lambda x, n, axis: torch.repeat_interleave(x, n, dim=axis))(k_cache, rep, axis=1)
    v = (lambda x, n, axis: torch.repeat_interleave(x, n, dim=axis))(v_cache, rep, axis=1)
    scores = torch.einsum("bhqd,bhkd->bhqk", q, k) * (Dh ** -0.5)
    p = _softmax(scores, axis=-1)
    o = torch.einsum("bhqk,bhkd->bhqd", p, v)
    return (lambda x, *d: x.permute(*d))(o, 0, 2, 1, 3).reshape(B, Sq, Hq * Dh) @ wo
```

```asm
; @launch kernel=standalone__gqa_block_cached__near_ridge_kernel grid=(256,1,1) block=(512,1,1) lds=163840
; @launch kernel=gqa_reduce_kernel grid=(256,1,1) block=(256,1,1) lds=0
.amdgcn_target "amdgcn-amd-amdhsa--gfx950"
.text
.globl standalone__gqa_block_cached__near_ridge_kernel
.p2align 8
.type standalone__gqa_block_cached__near_ridge_kernel,@function
standalone__gqa_block_cached__near_ridge_kernel:
    s_cmp_ge_u32 s2, 256
    s_cbranch_scc1 L_exit
    s_load_dwordx16 s[4:19], s[0:1], 0
    s_and_b32 s21, s2, 7
    s_lshr_b32 s20, s2, 3
    v_lshrrev_b32 v1, 6, v0
    s_nop 0
    v_readfirstlane_b32 s22, v1
    s_mov_b32 s54, 0x05040100
    s_mov_b32 s55, 0x07060302
    s_waitcnt lgkmcnt(0)
    s_mov_b32 s24, s4
    s_and_b32 s25, s5, 0xffff
    s_mov_b32 s26, 32768
    s_mov_b32 s27, 0x00020000
    s_mov_b32 s28, s6
    s_and_b32 s29, s7, 0xffff
    s_mov_b32 s30, 131072
    s_mov_b32 s31, 0x00020000
    s_mov_b32 s32, s8
    s_and_b32 s33, s9, 0xffff
    s_mov_b32 s34, 131072
    s_mov_b32 s35, 0x00020000
    s_mov_b32 s36, s10
    s_and_b32 s37, s11, 0xffff
    s_mov_b32 s38, 4194304
    s_mov_b32 s39, 0x00020000
    s_mov_b32 s40, s12
    s_and_b32 s41, s13, 0xffff
    s_mov_b32 s42, 4194304
    s_mov_b32 s43, 0x00020000
    s_mov_b32 s44, s18
    s_and_b32 s45, s19, 0xffff
    s_mov_b32 s46, 262144
    s_mov_b32 s47, 0x00020000
    s_lshl_b32 s51, s20, 15
    s_add_u32 s24, s24, s51
    s_addc_u32 s25, s25, 0
    s_lshl_b32 s51, s2, 17
    s_add_u32 s28, s28, s51
    s_addc_u32 s29, s29, 0
    s_add_u32 s32, s32, s51
    s_addc_u32 s33, s33, 0
    s_lshl_b32 s51, s20, 18
    s_add_u32 s44, s44, s51
    s_addc_u32 s45, s45, 0
    s_cmp_ge_u32 s22, 4
    s_cbranch_scc1 L_kvload
L_compute:
    v_and_b32 v28, 63, v0
    s_lshl_b32 s51, s22, 13
    s_and_b32 s52, s22, 1
    s_lshl_b32 s52, s52, 3
    s_add_u32 s53, s52, 0
    v_xor_b32 v24, s53, v28
    v_lshlrev_b32 v24, 4, v24
    s_add_u32 s48, s51, 0
    s_add_u32 m0, s51, 131072
    s_nop 0
    buffer_load_dwordx4 v24, s[24:27], s48 offen offset:0 lds
    s_add_u32 s53, s52, 1
    v_xor_b32 v25, s53, v28
    v_lshlrev_b32 v25, 4, v25
    buffer_load_dwordx4 v25, s[24:27], s48 offen offset:1024 lds
    s_add_u32 s53, s52, 2
    v_xor_b32 v26, s53, v28
    v_lshlrev_b32 v26, 4, v26
    buffer_load_dwordx4 v26, s[24:27], s48 offen offset:2048 lds
    s_add_u32 s53, s52, 3
    v_xor_b32 v27, s53, v28
    v_lshlrev_b32 v27, 4, v27
    buffer_load_dwordx4 v27, s[24:27], s48 offen offset:3072 lds
    s_add_u32 s53, s52, 4
    v_xor_b32 v24, s53, v28
    v_lshlrev_b32 v24, 4, v24
    s_add_u32 s48, s51, 4096
    s_add_u32 m0, s51, 135168
    s_nop 0
    buffer_load_dwordx4 v24, s[24:27], s48 offen offset:0 lds
    s_add_u32 s53, s52, 5
    v_xor_b32 v25, s53, v28
    v_lshlrev_b32 v25, 4, v25
    buffer_load_dwordx4 v25, s[24:27], s48 offen offset:1024 lds
    s_add_u32 s53, s52, 6
    v_xor_b32 v26, s53, v28
    v_lshlrev_b32 v26, 4, v26
    buffer_load_dwordx4 v26, s[24:27], s48 offen offset:2048 lds
    s_add_u32 s53, s52, 7
    v_xor_b32 v27, s53, v28
    v_lshlrev_b32 v27, 4, v27
    buffer_load_dwordx4 v27, s[24:27], s48 offen offset:3072 lds
    v_and_b32 v24, 15, v28
    v_lshlrev_b32 v24, 4, v24
    v_lshrrev_b32 v25, 4, v28
    v_lshlrev_b32 v25, 16, v25
    v_add_u32 v1, v24, v25
    v_add_u32 v2, 8192, v1
    v_add_u32 v3, 16384, v1
    v_add_u32 v4, 24576, v1
    v_add_u32 v5, 32768, v1
    v_add_u32 v6, 40960, v1
    v_add_u32 v7, 49152, v1
    v_add_u32 v8, 57344, v1
    s_lshl_b32 s49, s22, 8
    s_lshl_b32 s52, s21, 10
    s_add_u32 s52, s52, s49
    s_add_u32 s36, s36, s52
    s_addc_u32 s37, s37, 0
    s_sub_u32 s38, s38, s52
    s_lshl_b32 s52, s21, 19
    s_add_u32 s52, s52, s49
    s_add_u32 s40, s40, s52
    s_addc_u32 s41, s41, 0
    s_sub_u32 s42, s42, s52
    s_mov_b32 s48, 0
    buffer_load_dwordx4 v[128:131], v1, s[36:39], s48 offen offset:0
    buffer_load_dwordx4 v[132:135], v2, s[36:39], s48 offen offset:0
    buffer_load_dwordx4 v[136:139], v3, s[36:39], s48 offen offset:0
    buffer_load_dwordx4 v[140:143], v4, s[36:39], s48 offen offset:0
    buffer_load_dwordx4 v[144:147], v5, s[36:39], s48 offen offset:0
    buffer_load_dwordx4 v[148:151], v6, s[36:39], s48 offen offset:0
    buffer_load_dwordx4 v[152:155], v7, s[36:39], s48 offen offset:0
    buffer_load_dwordx4 v[156:159], v8, s[36:39], s48 offen offset:0
    s_mov_b32 s48, 262144
    buffer_load_dwordx4 v[160:163], v1, s[36:39], s48 offen offset:0
    buffer_load_dwordx4 v[164:167], v2, s[36:39], s48 offen offset:0
    buffer_load_dwordx4 v[168:171], v3, s[36:39], s48 offen offset:0
    buffer_load_dwordx4 v[172:175], v4, s[36:39], s48 offen offset:0
    buffer_load_dwordx4 v[176:179], v5, s[36:39], s48 offen offset:0
    buffer_load_dwordx4 v[180:183], v6, s[36:39], s48 offen offset:0
    buffer_load_dwordx4 v[184:187], v7, s[36:39], s48 offen offset:0
    buffer_load_dwordx4 v[188:191], v8, s[36:39], s48 offen offset:0
    s_mov_b32 s48, 524288
    buffer_load_dwordx4 v[192:195], v1, s[36:39], s48 offen offset:0
    buffer_load_dwordx4 v[196:199], v2, s[36:39], s48 offen offset:0
    buffer_load_dwordx4 v[200:203], v3, s[36:39], s48 offen offset:0
    buffer_load_dwordx4 v[204:207], v4, s[36:39], s48 offen offset:0
    buffer_load_dwordx4 v[208:211], v5, s[36:39], s48 offen offset:0
    buffer_load_dwordx4 v[212:215], v6, s[36:39], s48 offen offset:0
    buffer_load_dwordx4 v[216:219], v7, s[36:39], s48 offen offset:0
    buffer_load_dwordx4 v[220:223], v8, s[36:39], s48 offen offset:0
    v_and_b32 v24, 15, v28
    v_lshrrev_b32 v25, 4, v28
    v_xor_b32 v25, v25, v24
    v_lshlrev_b32 v25, 4, v25
    v_lshlrev_b32 v24, 10, v24
    v_add_u32 v24, 131072, v24
    v_xor_b32 v13, 0, v25
    v_add_u32 v13, v13, v24
    v_xor_b32 v14, 64, v25
    v_add_u32 v14, v14, v24
    v_xor_b32 v15, 128, v25
    v_add_u32 v15, v15, v24
    v_xor_b32 v16, 192, v25
    v_add_u32 v16, v16, v24
    s_mov_b32 s50, 0x3e0293ee
    s_waitcnt vmcnt(24)
    s_barrier
    ds_read_b128 v[96:99], v13 offset:0
    ds_read_b128 v[100:103], v13 offset:16384
    ds_read_b128 v[104:107], v14 offset:0
    ds_read_b128 v[108:111], v14 offset:16384
    s_waitcnt vmcnt(16)
    v_perm_b32 v224, v132, v128, s54
    v_perm_b32 v225, v140, v136, s54
    v_perm_b32 v226, v148, v144, s54
    v_perm_b32 v227, v156, v152, s54
    v_perm_b32 v228, v132, v128, s55
    v_perm_b32 v229, v140, v136, s55
    s_waitcnt lgkmcnt(2)
    v_mfma_f32_16x16x32_bf16 v[32:35], v[224:227], v[96:99], 0
    v_perm_b32 v230, v148, v144, s55
    v_perm_b32 v231, v156, v152, s55
    v_mfma_f32_16x16x32_bf16 v[36:39], v[224:227], v[100:103], 0
    v_perm_b32 v232, v133, v129, s54
    v_perm_b32 v233, v141, v137, s54
    v_mfma_f32_16x16x32_bf16 v[40:43], v[228:231], v[96:99], 0
    v_perm_b32 v234, v149, v145, s54
    v_perm_b32 v235, v157, v153, s54
    v_mfma_f32_16x16x32_bf16 v[44:47], v[228:231], v[100:103], 0
    v_perm_b32 v236, v133, v129, s55
    v_perm_b32 v237, v141, v137, s55
    v_mfma_f32_16x16x32_bf16 v[48:51], v[232:235], v[96:99], 0
    v_perm_b32 v238, v149, v145, s55
    v_perm_b32 v239, v157, v153, s55
    v_mfma_f32_16x16x32_bf16 v[52:55], v[232:235], v[100:103], 0
    v_perm_b32 v240, v134, v130, s54
    v_perm_b32 v241, v142, v138, s54
    v_mfma_f32_16x16x32_bf16 v[56:59], v[236:239], v[96:99], 0
    v_perm_b32 v242, v150, v146, s54
    v_perm_b32 v243, v158, v154, s54
    v_mfma_f32_16x16x32_bf16 v[60:63], v[236:239], v[100:103], 0
    v_perm_b32 v244, v134, v130, s55
    v_perm_b32 v245, v142, v138, s55
    v_mfma_f32_16x16x32_bf16 v[64:67], v[240:243], v[96:99], 0
    v_perm_b32 v246, v150, v146, s55
    v_perm_b32 v247, v158, v154, s55
    v_mfma_f32_16x16x32_bf16 v[68:71], v[240:243], v[100:103], 0
    v_perm_b32 v248, v135, v131, s54
    v_perm_b32 v249, v143, v139, s54
    v_mfma_f32_16x16x32_bf16 v[72:75], v[244:247], v[96:99], 0
    v_perm_b32 v250, v151, v147, s54
    v_perm_b32 v251, v159, v155, s54
    v_mfma_f32_16x16x32_bf16 v[76:79], v[244:247], v[100:103], 0
    v_perm_b32 v252, v135, v131, s55
    v_perm_b32 v253, v143, v139, s55
    v_mfma_f32_16x16x32_bf16 v[80:83], v[248:251], v[96:99], 0
    v_perm_b32 v254, v151, v147, s55
    v_perm_b32 v255, v159, v155, s55
    v_mfma_f32_16x16x32_bf16 v[84:87], v[248:251], v[100:103], 0
    s_waitcnt vmcnt(8)
    v_perm_b32 v224, v164, v160, s54
    v_perm_b32 v225, v172, v168, s54
    v_mfma_f32_16x16x32_bf16 v[88:91], v[252:255], v[96:99], 0
    v_perm_b32 v226, v180, v176, s54
    v_perm_b32 v227, v188, v184, s54
    v_mfma_f32_16x16x32_bf16 v[92:95], v[252:255], v[100:103], 0
    ds_read_b128 v[96:99], v15 offset:0
    ds_read_b128 v[100:103], v15 offset:16384
    v_perm_b32 v228, v164, v160, s55
    v_perm_b32 v229, v172, v168, s55
    s_waitcnt lgkmcnt(2)
    v_mfma_f32_16x16x32_bf16 v[32:35], v[224:227], v[104:107], v[32:35]
    s_mov_b32 s48, 786432
    buffer_load_dwordx4 v[128:131], v1, s[36:39], s48 offen offset:0
    v_perm_b32 v230, v180, v176, s55
    v_perm_b32 v231, v188, v184, s55
    v_mfma_f32_16x16x32_bf16 v[36:39], v[224:227], v[108:111], v[36:39]
    v_perm_b32 v232, v165, v161, s54
    v_perm_b32 v233, v173, v169, s54
    v_mfma_f32_16x16x32_bf16 v[40:43], v[228:231], v[104:107], v[40:43]
    buffer_load_dwordx4 v[132:135], v2, s[36:39], s48 offen offset:0
    v_perm_b32 v234, v181, v177, s54
    v_perm_b32 v235, v189, v185, s54
    v_mfma_f32_16x16x32_bf16 v[44:47], v[228:231], v[108:111], v[44:47]
    v_perm_b32 v236, v165, v161, s55
    v_perm_b32 v237, v173, v169, s55
    v_mfma_f32_16x16x32_bf16 v[48:51], v[232:235], v[104:107], v[48:51]
    buffer_load_dwordx4 v[136:139], v3, s[36:39], s48 offen offset:0
    v_perm_b32 v238, v181, v177, s55
    v_perm_b32 v239, v189, v185, s55
    v_mfma_f32_16x16x32_bf16 v[52:55], v[232:235], v[108:111], v[52:55]
    v_perm_b32 v240, v166, v162, s54
    v_perm_b32 v241, v174, v170, s54
    v_mfma_f32_16x16x32_bf16 v[56:59], v[236:239], v[104:107], v[56:59]
    buffer_load_dwordx4 v[140:143], v4, s[36:39], s48 offen offset:0
    v_perm_b32 v242, v182, v178, s54
    v_perm_b32 v243, v190, v186, s54
    v_mfma_f32_16x16x32_bf16 v[60:63], v[236:239], v[108:111], v[60:63]
    v_perm_b32 v244, v166, v162, s55
    v_perm_b32 v245, v174, v170, s55
    v_mfma_f32_16x16x32_bf16 v[64:67], v[240:243], v[104:107], v[64:67]
    buffer_load_dwordx4 v[144:147], v5, s[36:39], s48 offen offset:0
    v_perm_b32 v246, v182, v178, s55
    v_perm_b32 v247, v190, v186, s55
    v_mfma_f32_16x16x32_bf16 v[68:71], v[240:243], v[108:111], v[68:71]
    v_perm_b32 v248, v167, v163, s54
    v_perm_b32 v249, v175, v171, s54
    v_mfma_f32_16x16x32_bf16 v[72:75], v[244:247], v[104:107], v[72:75]
    buffer_load_dwordx4 v[148:151], v6, s[36:39], s48 offen offset:0
    v_perm_b32 v250, v183, v179, s54
    v_perm_b32 v251, v191, v187, s54
    v_mfma_f32_16x16x32_bf16 v[76:79], v[244:247], v[108:111], v[76:79]
    v_perm_b32 v252, v167, v163, s55
    v_perm_b32 v253, v175, v171, s55
    v_mfma_f32_16x16x32_bf16 v[80:83], v[248:251], v[104:107], v[80:83]
    buffer_load_dwordx4 v[152:155], v7, s[36:39], s48 offen offset:0
    v_perm_b32 v254, v183, v179, s55
    v_perm_b32 v255, v191, v187, s55
    v_mfma_f32_16x16x32_bf16 v[84:87], v[248:251], v[108:111], v[84:87]
    s_waitcnt vmcnt(7)
    v_perm_b32 v224, v196, v192, s54
    v_perm_b32 v225, v204, v200, s54
    v_mfma_f32_16x16x32_bf16 v[88:91], v[252:255], v[104:107], v[88:91]
    buffer_load_dwordx4 v[156:159], v8, s[36:39], s48 offen offset:0
    v_perm_b32 v226, v212, v208, s54
    v_perm_b32 v227, v220, v216, s54
    v_mfma_f32_16x16x32_bf16 v[92:95], v[252:255], v[108:111], v[92:95]
    ds_read_b128 v[104:107], v16 offset:0
    ds_read_b128 v[108:111], v16 offset:16384
    v_perm_b32 v228, v196, v192, s55
    v_perm_b32 v229, v204, v200, s55
    s_waitcnt lgkmcnt(2)
    v_mfma_f32_16x16x32_bf16 v[32:35], v[224:227], v[96:99], v[32:35]
    s_mov_b32 s48, 1048576
    buffer_load_dwordx4 v[160:163], v1, s[36:39], s48 offen offset:0
    v_perm_b32 v230, v212, v208, s55
    v_perm_b32 v231, v220, v216, s55
    v_mfma_f32_16x16x32_bf16 v[36:39], v[224:227], v[100:103], v[36:39]
    v_perm_b32 v232, v197, v193, s54
    v_perm_b32 v233, v205, v201, s54
    v_mfma_f32_16x16x32_bf16 v[40:43], v[228:231], v[96:99], v[40:43]
    buffer_load_dwordx4 v[164:167], v2, s[36:39], s48 offen offset:0
    v_perm_b32 v234, v213, v209, s54
    v_perm_b32 v235, v221, v217, s54
    v_mfma_f32_16x16x32_bf16 v[44:47], v[228:231], v[100:103], v[44:47]
    v_perm_b32 v236, v197, v193, s55
    v_perm_b32 v237, v205, v201, s55
    v_mfma_f32_16x16x32_bf16 v[48:51], v[232:235], v[96:99], v[48:51]
    buffer_load_dwordx4 v[168:171], v3, s[36:39], s48 offen offset:0
    v_perm_b32 v238, v213, v209, s55
    v_perm_b32 v239, v221, v217, s55
    v_mfma_f32_16x16x32_bf16 v[52:55], v[232:235], v[100:103], v[52:55]
    v_perm_b32 v240, v198, v194, s54
    v_perm_b32 v241, v206, v202, s54
    v_mfma_f32_16x16x32_bf16 v[56:59], v[236:239], v[96:99], v[56:59]
    buffer_load_dwordx4 v[172:175], v4, s[36:39], s48 offen offset:0
    v_perm_b32 v242, v214, v210, s54
    v_perm_b32 v243, v222, v218, s54
    v_mfma_f32_16x16x32_bf16 v[60:63], v[236:239], v[100:103], v[60:63]
    v_perm_b32 v244, v198, v194, s55
    v_perm_b32 v245, v206, v202, s55
    v_mfma_f32_16x16x32_bf16 v[64:67], v[240:243], v[96:99], v[64:67]
    buffer_load_dwordx4 v[176:179], v5, s[36:39], s48 offen offset:0
    v_perm_b32 v246, v214, v210, s55
    v_perm_b32 v247, v222, v218, s55
    v_mfma_f32_16x16x32_bf16 v[68:71], v[240:243], v[100:103], v[68:71]
    v_perm_b32 v248, v199, v195, s54
    v_perm_b32 v249, v207, v203, s54
    v_mfma_f32_16x16x32_bf16 v[72:75], v[244:247], v[96:99], v[72:75]
    buffer_load_dwordx4 v[180:183], v6, s[36:39], s48 offen offset:0
    v_perm_b32 v250, v215, v211, s54
    v_perm_b32 v251, v223, v219, s54
    v_mfma_f32_16x16x32_bf16 v[76:79], v[244:247], v[100:103], v[76:79]
    v_perm_b32 v252, v199, v195, s55
    v_perm_b32 v253, v207, v203, s55
    v_mfma_f32_16x16x32_bf16 v[80:83], v[248:251], v[96:99], v[80:83]
    buffer_load_dwordx4 v[184:187], v7, s[36:39], s48 offen offset:0
    v_perm_b32 v254, v215, v211, s55
    v_perm_b32 v255, v223, v219, s55
    v_mfma_f32_16x16x32_bf16 v[84:87], v[248:251], v[100:103], v[84:87]
    s_waitcnt vmcnt(7)
    v_perm_b32 v224, v132, v128, s54
    v_perm_b32 v225, v140, v136, s54
    v_mfma_f32_16x16x32_bf16 v[88:91], v[252:255], v[96:99], v[88:91]
    buffer_load_dwordx4 v[188:191], v8, s[36:39], s48 offen offset:0
    v_perm_b32 v226, v148, v144, s54
    v_perm_b32 v227, v156, v152, s54
    v_mfma_f32_16x16x32_bf16 v[92:95], v[252:255], v[100:103], v[92:95]
    ds_read_b128 v[96:99], v13 offset:256
    ds_read_b128 v[100:103], v13 offset:16640
    v_perm_b32 v228, v132, v128, s55
    v_perm_b32 v229, v140, v136, s55
    s_waitcnt lgkmcnt(2)
    v_mfma_f32_16x16x32_bf16 v[32:35], v[224:227], v[104:107], v[32:35]
    s_mov_b32 s48, 1310720
    buffer_load_dwordx4 v[192:195], v1, s[36:39], s48 offen offset:0
    v_perm_b32 v230, v148, v144, s55
    v_perm_b32 v231, v156, v152, s55
    v_mfma_f32_16x16x32_bf16 v[36:39], v[224:227], v[108:111], v[36:39]
    v_perm_b32 v232, v133, v129, s54
    v_perm_b32 v233, v141, v137, s54
    v_mfma_f32_16x16x32_bf16 v[40:43], v[228:231], v[104:107], v[40:43]
    buffer_load_dwordx4 v[196:199], v2, s[36:39], s48 offen offset:0
    v_perm_b32 v234, v149, v145, s54
    v_perm_b32 v235, v157, v153, s54
    v_mfma_f32_16x16x32_bf16 v[44:47], v[228:231], v[108:111], v[44:47]
    v_perm_b32 v236, v133, v129, s55
    v_perm_b32 v237, v141, v137, s55
    v_mfma_f32_16x16x32_bf16 v[48:51], v[232:235], v[104:107], v[48:51]
    buffer_load_dwordx4 v[200:203], v3, s[36:39], s48 offen offset:0
    v_perm_b32 v238, v149, v145, s55
    v_perm_b32 v239, v157, v153, s55
    v_mfma_f32_16x16x32_bf16 v[52:55], v[232:235], v[108:111], v[52:55]
    v_perm_b32 v240, v134, v130, s54
    v_perm_b32 v241, v142, v138, s54
    v_mfma_f32_16x16x32_bf16 v[56:59], v[236:239], v[104:107], v[56:59]
    buffer_load_dwordx4 v[204:207], v4, s[36:39], s48 offen offset:0
    v_perm_b32 v242, v150, v146, s54
    v_perm_b32 v243, v158, v154, s54
    v_mfma_f32_16x16x32_bf16 v[60:63], v[236:239], v[108:111], v[60:63]
    v_perm_b32 v244, v134, v130, s55
    v_perm_b32 v245, v142, v138, s55
    v_mfma_f32_16x16x32_bf16 v[64:67], v[240:243], v[104:107], v[64:67]
    buffer_load_dwordx4 v[208:211], v5, s[36:39], s48 offen offset:0
    v_perm_b32 v246, v150, v146, s55
    v_perm_b32 v247, v158, v154, s55
    v_mfma_f32_16x16x32_bf16 v[68:71], v[240:243], v[108:111], v[68:71]
    v_perm_b32 v248, v135, v131, s54
    v_perm_b32 v249, v143, v139, s54
    v_mfma_f32_16x16x32_bf16 v[72:75], v[244:247], v[104:107], v[72:75]
    buffer_load_dwordx4 v[212:215], v6, s[36:39], s48 offen offset:0
    v_perm_b32 v250, v151, v147, s54
    v_perm_b32 v251, v159, v155, s54
    v_mfma_f32_16x16x32_bf16 v[76:79], v[244:247], v[108:111], v[76:79]
    v_perm_b32 v252, v135, v131, s55
    v_perm_b32 v253, v143, v139, s55
    v_mfma_f32_16x16x32_bf16 v[80:83], v[248:251], v[104:107], v[80:83]
    buffer_load_dwordx4 v[216:219], v7, s[36:39], s48 offen offset:0
    v_perm_b32 v254, v151, v147, s55
    v_perm_b32 v255, v159, v155, s55
    v_mfma_f32_16x16x32_bf16 v[84:87], v[248:251], v[108:111], v[84:87]
    s_waitcnt vmcnt(7)
    v_perm_b32 v224, v164, v160, s54
    v_perm_b32 v225, v172, v168, s54
    v_mfma_f32_16x16x32_bf16 v[88:91], v[252:255], v[104:107], v[88:91]
    buffer_load_dwordx4 v[220:223], v8, s[36:39], s48 offen offset:0
    v_perm_b32 v226, v180, v176, s54
    v_perm_b32 v227, v188, v184, s54
    v_mfma_f32_16x16x32_bf16 v[92:95], v[252:255], v[108:111], v[92:95]
    ds_read_b128 v[104:107], v14 offset:256
    ds_read_b128 v[108:111], v14 offset:16640
    v_perm_b32 v228, v164, v160, s55
    v_perm_b32 v229, v172, v168, s55
    s_waitcnt lgkmcnt(2)
    v_mfma_f32_16x16x32_bf16 v[32:35], v[224:227], v[96:99], v[32:35]
    s_mov_b32 s48, 1572864
    buffer_load_dwordx4 v[128:131], v1, s[36:39], s48 offen offset:0
    v_perm_b32 v230, v180, v176, s55
    v_perm_b32 v231, v188, v184, s55
    v_mfma_f32_16x16x32_bf16 v[36:39], v[224:227], v[100:103], v[36:39]
    v_perm_b32 v232, v165, v161, s54
    v_perm_b32 v233, v173, v169, s54
    v_mfma_f32_16x16x32_bf16 v[40:43], v[228:231], v[96:99], v[40:43]
    buffer_load_dwordx4 v[132:135], v2, s[36:39], s48 offen offset:0
    v_perm_b32 v234, v181, v177, s54
    v_perm_b32 v235, v189, v185, s54
    v_mfma_f32_16x16x32_bf16 v[44:47], v[228:231], v[100:103], v[44:47]
    v_perm_b32 v236, v165, v161, s55
    v_perm_b32 v237, v173, v169, s55
    v_mfma_f32_16x16x32_bf16 v[48:51], v[232:235], v[96:99], v[48:51]
    buffer_load_dwordx4 v[136:139], v3, s[36:39], s48 offen offset:0
    v_perm_b32 v238, v181, v177, s55
    v_perm_b32 v239, v189, v185, s55
    v_mfma_f32_16x16x32_bf16 v[52:55], v[232:235], v[100:103], v[52:55]
    v_perm_b32 v240, v166, v162, s54
    v_perm_b32 v241, v174, v170, s54
    v_mfma_f32_16x16x32_bf16 v[56:59], v[236:239], v[96:99], v[56:59]
    buffer_load_dwordx4 v[140:143], v4, s[36:39], s48 offen offset:0
    v_perm_b32 v242, v182, v178, s54
    v_perm_b32 v243, v190, v186, s54
    v_mfma_f32_16x16x32_bf16 v[60:63], v[236:239], v[100:103], v[60:63]
    v_perm_b32 v244, v166, v162, s55
    v_perm_b32 v245, v174, v170, s55
    v_mfma_f32_16x16x32_bf16 v[64:67], v[240:243], v[96:99], v[64:67]
    buffer_load_dwordx4 v[144:147], v5, s[36:39], s48 offen offset:0
    v_perm_b32 v246, v182, v178, s55
    v_perm_b32 v247, v190, v186, s55
    v_mfma_f32_16x16x32_bf16 v[68:71], v[240:243], v[100:103], v[68:71]
    v_perm_b32 v248, v167, v163, s54
    v_perm_b32 v249, v175, v171, s54
    v_mfma_f32_16x16x32_bf16 v[72:75], v[244:247], v[96:99], v[72:75]
    buffer_load_dwordx4 v[148:151], v6, s[36:39], s48 offen offset:0
    v_perm_b32 v250, v183, v179, s54
    v_perm_b32 v251, v191, v187, s54
    v_mfma_f32_16x16x32_bf16 v[76:79], v[244:247], v[100:103], v[76:79]
    v_perm_b32 v252, v167, v163, s55
    v_perm_b32 v253, v175, v171, s55
    v_mfma_f32_16x16x32_bf16 v[80:83], v[248:251], v[96:99], v[80:83]
    buffer_load_dwordx4 v[152:155], v7, s[36:39], s48 offen offset:0
    v_perm_b32 v254, v183, v179, s55
    v_perm_b32 v255, v191, v187, s55
    v_mfma_f32_16x16x32_bf16 v[84:87], v[248:251], v[100:103], v[84:87]
    s_waitcnt vmcnt(7)
    v_perm_b32 v224, v196, v192, s54
    v_perm_b32 v225, v204, v200, s54
    v_mfma_f32_16x16x32_bf16 v[88:91], v[252:255], v[96:99], v[88:91]
    buffer_load_dwordx4 v[156:159], v8, s[36:39], s48 offen offset:0
    v_perm_b32 v226, v212, v208, s54
    v_perm_b32 v227, v220, v216, s54
    v_mfma_f32_16x16x32_bf16 v[92:95], v[252:255], v[100:103], v[92:95]
    ds_read_b128 v[96:99], v15 offset:256
    ds_read_b128 v[100:103], v15 offset:16640
    v_perm_b32 v228, v196, v192, s55
    v_perm_b32 v229, v204, v200, s55
    s_waitcnt lgkmcnt(2)
    v_mfma_f32_16x16x32_bf16 v[32:35], v[224:227], v[104:107], v[32:35]
    s_mov_b32 s48, 1835008
    buffer_load_dwordx4 v[160:163], v1, s[36:39], s48 offen offset:0
    v_perm_b32 v230, v212, v208, s55
    v_perm_b32 v231, v220, v216, s55
    v_mfma_f32_16x16x32_bf16 v[36:39], v[224:227], v[108:111], v[36:39]
    v_perm_b32 v232, v197, v193, s54
    v_perm_b32 v233, v205, v201, s54
    v_mfma_f32_16x16x32_bf16 v[40:43], v[228:231], v[104:107], v[40:43]
    buffer_load_dwordx4 v[164:167], v2, s[36:39], s48 offen offset:0
    v_perm_b32 v234, v213, v209, s54
    v_perm_b32 v235, v221, v217, s54
    v_mfma_f32_16x16x32_bf16 v[44:47], v[228:231], v[108:111], v[44:47]
    v_perm_b32 v236, v197, v193, s55
    v_perm_b32 v237, v205, v201, s55
    v_mfma_f32_16x16x32_bf16 v[48:51], v[232:235], v[104:107], v[48:51]
    buffer_load_dwordx4 v[168:171], v3, s[36:39], s48 offen offset:0
    v_perm_b32 v238, v213, v209, s55
    v_perm_b32 v239, v221, v217, s55
    v_mfma_f32_16x16x32_bf16 v[52:55], v[232:235], v[108:111], v[52:55]
    v_perm_b32 v240, v198, v194, s54
    v_perm_b32 v241, v206, v202, s54
    v_mfma_f32_16x16x32_bf16 v[56:59], v[236:239], v[104:107], v[56:59]
    buffer_load_dwordx4 v[172:175], v4, s[36:39], s48 offen offset:0
    v_perm_b32 v242, v214, v210, s54
    v_perm_b32 v243, v222, v218, s54
    v_mfma_f32_16x16x32_bf16 v[60:63], v[236:239], v[108:111], v[60:63]
    v_perm_b32 v244, v198, v194, s55
    v_perm_b32 v245, v206, v202, s55
    v_mfma_f32_16x16x32_bf16 v[64:67], v[240:243], v[104:107], v[64:67]
    buffer_load_dwordx4 v[176:179], v5, s[36:39], s48 offen offset:0
    v_perm_b32 v246, v214, v210, s55
    v_perm_b32 v247, v222, v218, s55
    v_mfma_f32_16x16x32_bf16 v[68:71], v[240:243], v[108:111], v[68:71]
    v_perm_b32 v248, v199, v195, s54
    v_perm_b32 v249, v207, v203, s54
    v_mfma_f32_16x16x32_bf16 v[72:75], v[244:247], v[104:107], v[72:75]
    buffer_load_dwordx4 v[180:183], v6, s[36:39], s48 offen offset:0
    v_perm_b32 v250, v215, v211, s54
    v_perm_b32 v251, v223, v219, s54
    v_mfma_f32_16x16x32_bf16 v[76:79], v[244:247], v[108:111], v[76:79]
    v_perm_b32 v252, v199, v195, s55
    v_perm_b32 v253, v207, v203, s55
    v_mfma_f32_16x16x32_bf16 v[80:83], v[248:251], v[104:107], v[80:83]
    buffer_load_dwordx4 v[184:187], v7, s[36:39], s48 offen offset:0
    v_perm_b32 v254, v215, v211, s55
    v_perm_b32 v255, v223, v219, s55
    v_mfma_f32_16x16x32_bf16 v[84:87], v[248:251], v[108:111], v[84:87]
    s_waitcnt vmcnt(7)
    v_perm_b32 v224, v132, v128, s54
    v_perm_b32 v225, v140, v136, s54
    v_mfma_f32_16x16x32_bf16 v[88:91], v[252:255], v[104:107], v[88:91]
    buffer_load_dwordx4 v[188:191], v8, s[36:39], s48 offen offset:0
    v_perm_b32 v226, v148, v144, s54
    v_perm_b32 v227, v156, v152, s54
    v_mfma_f32_16x16x32_bf16 v[92:95], v[252:255], v[108:111], v[92:95]
    ds_read_b128 v[104:107], v16 offset:256
    ds_read_b128 v[108:111], v16 offset:16640
    v_perm_b32 v228, v132, v128, s55
    v_perm_b32 v229, v140, v136, s55
    s_waitcnt lgkmcnt(2)
    v_mfma_f32_16x16x32_bf16 v[32:35], v[224:227], v[96:99], v[32:35]
    s_mov_b32 s48, 2097152
    buffer_load_dwordx4 v[192:195], v1, s[36:39], s48 offen offset:0
    v_perm_b32 v230, v148, v144, s55
    v_perm_b32 v231, v156, v152, s55
    v_mfma_f32_16x16x32_bf16 v[36:39], v[224:227], v[100:103], v[36:39]
    v_perm_b32 v232, v133, v129, s54
    v_perm_b32 v233, v141, v137, s54
    v_mfma_f32_16x16x32_bf16 v[40:43], v[228:231], v[96:99], v[40:43]
    buffer_load_dwordx4 v[196:199], v2, s[36:39], s48 offen offset:0
    v_perm_b32 v234, v149, v145, s54
    v_perm_b32 v235, v157, v153, s54
    v_mfma_f32_16x16x32_bf16 v[44:47], v[228:231], v[100:103], v[44:47]
    v_perm_b32 v236, v133, v129, s55
    v_perm_b32 v237, v141, v137, s55
    v_mfma_f32_16x16x32_bf16 v[48:51], v[232:235], v[96:99], v[48:51]
    buffer_load_dwordx4 v[200:203], v3, s[36:39], s48 offen offset:0
    v_perm_b32 v238, v149, v145, s55
    v_perm_b32 v239, v157, v153, s55
    v_mfma_f32_16x16x32_bf16 v[52:55], v[232:235], v[100:103], v[52:55]
    v_perm_b32 v240, v134, v130, s54
    v_perm_b32 v241, v142, v138, s54
    v_mfma_f32_16x16x32_bf16 v[56:59], v[236:239], v[96:99], v[56:59]
    buffer_load_dwordx4 v[204:207], v4, s[36:39], s48 offen offset:0
    v_perm_b32 v242, v150, v146, s54
    v_perm_b32 v243, v158, v154, s54
    v_mfma_f32_16x16x32_bf16 v[60:63], v[236:239], v[100:103], v[60:63]
    v_perm_b32 v244, v134, v130, s55
    v_perm_b32 v245, v142, v138, s55
    v_mfma_f32_16x16x32_bf16 v[64:67], v[240:243], v[96:99], v[64:67]
    buffer_load_dwordx4 v[208:211], v5, s[36:39], s48 offen offset:0
    v_perm_b32 v246, v150, v146, s55
    v_perm_b32 v247, v158, v154, s55
    v_mfma_f32_16x16x32_bf16 v[68:71], v[240:243], v[100:103], v[68:71]
    v_perm_b32 v248, v135, v131, s54
    v_perm_b32 v249, v143, v139, s54
    v_mfma_f32_16x16x32_bf16 v[72:75], v[244:247], v[96:99], v[72:75]
    buffer_load_dwordx4 v[212:215], v6, s[36:39], s48 offen offset:0
    v_perm_b32 v250, v151, v147, s54
    v_perm_b32 v251, v159, v155, s54
    v_mfma_f32_16x16x32_bf16 v[76:79], v[244:247], v[100:103], v[76:79]
    v_perm_b32 v252, v135, v131, s55
    v_perm_b32 v253, v143, v139, s55
    v_mfma_f32_16x16x32_bf16 v[80:83], v[248:251], v[96:99], v[80:83]
    buffer_load_dwordx4 v[216:219], v7, s[36:39], s48 offen offset:0
    v_perm_b32 v254, v151, v147, s55
    v_perm_b32 v255, v159, v155, s55
    v_mfma_f32_16x16x32_bf16 v[84:87], v[248:251], v[100:103], v[84:87]
    s_waitcnt vmcnt(7)
    v_perm_b32 v224, v164, v160, s54
    v_perm_b32 v225, v172, v168, s54
    v_mfma_f32_16x16x32_bf16 v[88:91], v[252:255], v[96:99], v[88:91]
    buffer_load_dwordx4 v[220:223], v8, s[36:39], s48 offen offset:0
    v_perm_b32 v226, v180, v176, s54
    v_perm_b32 v227, v188, v184, s54
    v_mfma_f32_16x16x32_bf16 v[92:95], v[252:255], v[100:103], v[92:95]
    ds_read_b128 v[96:99], v13 offset:512
    ds_read_b128 v[100:103], v13 offset:16896
    v_perm_b32 v228, v164, v160, s55
    v_perm_b32 v229, v172, v168, s55
    s_waitcnt lgkmcnt(2)
    v_mfma_f32_16x16x32_bf16 v[32:35], v[224:227], v[104:107], v[32:35]
    s_mov_b32 s48, 2359296
    buffer_load_dwordx4 v[128:131], v1, s[36:39], s48 offen offset:0
    v_perm_b32 v230, v180, v176, s55
    v_perm_b32 v231, v188, v184, s55
    v_mfma_f32_16x16x32_bf16 v[36:39], v[224:227], v[108:111], v[36:39]
    v_perm_b32 v232, v165, v161, s54
    v_perm_b32 v233, v173, v169, s54
    v_mfma_f32_16x16x32_bf16 v[40:43], v[228:231], v[104:107], v[40:43]
    buffer_load_dwordx4 v[132:135], v2, s[36:39], s48 offen offset:0
    v_perm_b32 v234, v181, v177, s54
    v_perm_b32 v235, v189, v185, s54
    v_mfma_f32_16x16x32_bf16 v[44:47], v[228:231], v[108:111], v[44:47]
    v_perm_b32 v236, v165, v161, s55
    v_perm_b32 v237, v173, v169, s55
    v_mfma_f32_16x16x32_bf16 v[48:51], v[232:235], v[104:107], v[48:51]
    buffer_load_dwordx4 v[136:139], v3, s[36:39], s48 offen offset:0
    v_perm_b32 v238, v181, v177, s55
    v_perm_b32 v239, v189, v185, s55
    v_mfma_f32_16x16x32_bf16 v[52:55], v[232:235], v[108:111], v[52:55]
    v_perm_b32 v240, v166, v162, s54
    v_perm_b32 v241, v174, v170, s54
    v_mfma_f32_16x16x32_bf16 v[56:59], v[236:239], v[104:107], v[56:59]
    buffer_load_dwordx4 v[140:143], v4, s[36:39], s48 offen offset:0
    v_perm_b32 v242, v182, v178, s54
    v_perm_b32 v243, v190, v186, s54
    v_mfma_f32_16x16x32_bf16 v[60:63], v[236:239], v[108:111], v[60:63]
    v_perm_b32 v244, v166, v162, s55
    v_perm_b32 v245, v174, v170, s55
    v_mfma_f32_16x16x32_bf16 v[64:67], v[240:243], v[104:107], v[64:67]
    buffer_load_dwordx4 v[144:147], v5, s[36:39], s48 offen offset:0
    v_perm_b32 v246, v182, v178, s55
    v_perm_b32 v247, v190, v186, s55
    v_mfma_f32_16x16x32_bf16 v[68:71], v[240:243], v[108:111], v[68:71]
    v_perm_b32 v248, v167, v163, s54
    v_perm_b32 v249, v175, v171, s54
    v_mfma_f32_16x16x32_bf16 v[72:75], v[244:247], v[104:107], v[72:75]
    buffer_load_dwordx4 v[148:151], v6, s[36:39], s48 offen offset:0
    v_perm_b32 v250, v183, v179, s54
    v_perm_b32 v251, v191, v187, s54
    v_mfma_f32_16x16x32_bf16 v[76:79], v[244:247], v[108:111], v[76:79]
    v_perm_b32 v252, v167, v163, s55
    v_perm_b32 v253, v175, v171, s55
    v_mfma_f32_16x16x32_bf16 v[80:83], v[248:251], v[104:107], v[80:83]
    buffer_load_dwordx4 v[152:155], v7, s[36:39], s48 offen offset:0
    v_perm_b32 v254, v183, v179, s55
    v_perm_b32 v255, v191, v187, s55
    v_mfma_f32_16x16x32_bf16 v[84:87], v[248:251], v[108:111], v[84:87]
    s_waitcnt vmcnt(7)
    v_perm_b32 v224, v196, v192, s54
    v_perm_b32 v225, v204, v200, s54
    v_mfma_f32_16x16x32_bf16 v[88:91], v[252:255], v[104:107], v[88:91]
    buffer_load_dwordx4 v[156:159], v8, s[36:39], s48 offen offset:0
    v_perm_b32 v226, v212, v208, s54
    v_perm_b32 v227, v220, v216, s54
    v_mfma_f32_16x16x32_bf16 v[92:95], v[252:255], v[108:111], v[92:95]
    ds_read_b128 v[104:107], v14 offset:512
    ds_read_b128 v[108:111], v14 offset:16896
    v_perm_b32 v228, v196, v192, s55
    v_perm_b32 v229, v204, v200, s55
    s_waitcnt lgkmcnt(2)
    v_mfma_f32_16x16x32_bf16 v[32:35], v[224:227], v[96:99], v[32:35]
    s_mov_b32 s48, 2621440
    buffer_load_dwordx4 v[160:163], v1, s[36:39], s48 offen offset:0
    v_perm_b32 v230, v212, v208, s55
    v_perm_b32 v231, v220, v216, s55
    v_mfma_f32_16x16x32_bf16 v[36:39], v[224:227], v[100:103], v[36:39]
    v_perm_b32 v232, v197, v193, s54
    v_perm_b32 v233, v205, v201, s54
    v_mfma_f32_16x16x32_bf16 v[40:43], v[228:231], v[96:99], v[40:43]
    buffer_load_dwordx4 v[164:167], v2, s[36:39], s48 offen offset:0
    v_perm_b32 v234, v213, v209, s54
    v_perm_b32 v235, v221, v217, s54
    v_mfma_f32_16x16x32_bf16 v[44:47], v[228:231], v[100:103], v[44:47]
    v_perm_b32 v236, v197, v193, s55
    v_perm_b32 v237, v205, v201, s55
    v_mfma_f32_16x16x32_bf16 v[48:51], v[232:235], v[96:99], v[48:51]
    buffer_load_dwordx4 v[168:171], v3, s[36:39], s48 offen offset:0
    v_perm_b32 v238, v213, v209, s55
    v_perm_b32 v239, v221, v217, s55
    v_mfma_f32_16x16x32_bf16 v[52:55], v[232:235], v[100:103], v[52:55]
    v_perm_b32 v240, v198, v194, s54
    v_perm_b32 v241, v206, v202, s54
    v_mfma_f32_16x16x32_bf16 v[56:59], v[236:239], v[96:99], v[56:59]
    buffer_load_dwordx4 v[172:175], v4, s[36:39], s48 offen offset:0
    v_perm_b32 v242, v214, v210, s54
    v_perm_b32 v243, v222, v218, s54
    v_mfma_f32_16x16x32_bf16 v[60:63], v[236:239], v[100:103], v[60:63]
    v_perm_b32 v244, v198, v194, s55
    v_perm_b32 v245, v206, v202, s55
    v_mfma_f32_16x16x32_bf16 v[64:67], v[240:243], v[96:99], v[64:67]
    buffer_load_dwordx4 v[176:179], v5, s[36:39], s48 offen offset:0
    v_perm_b32 v246, v214, v210, s55
    v_perm_b32 v247, v222, v218, s55
    v_mfma_f32_16x16x32_bf16 v[68:71], v[240:243], v[100:103], v[68:71]
    v_perm_b32 v248, v199, v195, s54
    v_perm_b32 v249, v207, v203, s54
    v_mfma_f32_16x16x32_bf16 v[72:75], v[244:247], v[96:99], v[72:75]
    buffer_load_dwordx4 v[180:183], v6, s[36:39], s48 offen offset:0
    v_perm_b32 v250, v215, v211, s54
    v_perm_b32 v251, v223, v219, s54
    v_mfma_f32_16x16x32_bf16 v[76:79], v[244:247], v[100:103], v[76:79]
    v_perm_b32 v252, v199, v195, s55
    v_perm_b32 v253, v207, v203, s55
    v_mfma_f32_16x16x32_bf16 v[80:83], v[248:251], v[96:99], v[80:83]
    buffer_load_dwordx4 v[184:187], v7, s[36:39], s48 offen offset:0
    v_perm_b32 v254, v215, v211, s55
    v_perm_b32 v255, v223, v219, s55
    v_mfma_f32_16x16x32_bf16 v[84:87], v[248:251], v[100:103], v[84:87]
    s_waitcnt vmcnt(7)
    v_perm_b32 v224, v132, v128, s54
    v_perm_b32 v225, v140, v136, s54
    v_mfma_f32_16x16x32_bf16 v[88:91], v[252:255], v[96:99], v[88:91]
    buffer_load_dwordx4 v[188:191], v8, s[36:39], s48 offen offset:0
    v_perm_b32 v226, v148, v144, s54
    v_perm_b32 v227, v156, v152, s54
    v_mfma_f32_16x16x32_bf16 v[92:95], v[252:255], v[100:103], v[92:95]
    ds_read_b128 v[96:99], v15 offset:512
    ds_read_b128 v[100:103], v15 offset:16896
    v_perm_b32 v228, v132, v128, s55
    v_perm_b32 v229, v140, v136, s55
    s_waitcnt lgkmcnt(2)
    v_mfma_f32_16x16x32_bf16 v[32:35], v[224:227], v[104:107], v[32:35]
    s_mov_b32 s48, 2883584
    buffer_load_dwordx4 v[192:195], v1, s[36:39], s48 offen offset:0
    v_perm_b32 v230, v148, v144, s55
    v_perm_b32 v231, v156, v152, s55
    v_mfma_f32_16x16x32_bf16 v[36:39], v[224:227], v[108:111], v[36:39]
    v_perm_b32 v232, v133, v129, s54
    v_perm_b32 v233, v141, v137, s54
    v_mfma_f32_16x16x32_bf16 v[40:43], v[228:231], v[104:107], v[40:43]
    buffer_load_dwordx4 v[196:199], v2, s[36:39], s48 offen offset:0
    v_perm_b32 v234, v149, v145, s54
    v_perm_b32 v235, v157, v153, s54
    v_mfma_f32_16x16x32_bf16 v[44:47], v[228:231], v[108:111], v[44:47]
    v_perm_b32 v236, v133, v129, s55
    v_perm_b32 v237, v141, v137, s55
    v_mfma_f32_16x16x32_bf16 v[48:51], v[232:235], v[104:107], v[48:51]
    buffer_load_dwordx4 v[200:203], v3, s[36:39], s48 offen offset:0
    v_perm_b32 v238, v149, v145, s55
    v_perm_b32 v239, v157, v153, s55
    v_mfma_f32_16x16x32_bf16 v[52:55], v[232:235], v[108:111], v[52:55]
    v_perm_b32 v240, v134, v130, s54
    v_perm_b32 v241, v142, v138, s54
    v_mfma_f32_16x16x32_bf16 v[56:59], v[236:239], v[104:107], v[56:59]
    buffer_load_dwordx4 v[204:207], v4, s[36:39], s48 offen offset:0
    v_perm_b32 v242, v150, v146, s54
    v_perm_b32 v243, v158, v154, s54
    v_mfma_f32_16x16x32_bf16 v[60:63], v[236:239], v[108:111], v[60:63]
    v_perm_b32 v244, v134, v130, s55
    v_perm_b32 v245, v142, v138, s55
    v_mfma_f32_16x16x32_bf16 v[64:67], v[240:243], v[104:107], v[64:67]
    buffer_load_dwordx4 v[208:211], v5, s[36:39], s48 offen offset:0
    v_perm_b32 v246, v150, v146, s55
    v_perm_b32 v247, v158, v154, s55
    v_mfma_f32_16x16x32_bf16 v[68:71], v[240:243], v[108:111], v[68:71]
    v_perm_b32 v248, v135, v131, s54
    v_perm_b32 v249, v143, v139, s54
    v_mfma_f32_16x16x32_bf16 v[72:75], v[244:247], v[104:107], v[72:75]
    buffer_load_dwordx4 v[212:215], v6, s[36:39], s48 offen offset:0
    v_perm_b32 v250, v151, v147, s54
    v_perm_b32 v251, v159, v155, s54
    v_mfma_f32_16x16x32_bf16 v[76:79], v[244:247], v[108:111], v[76:79]
    v_perm_b32 v252, v135, v131, s55
    v_perm_b32 v253, v143, v139, s55
    v_mfma_f32_16x16x32_bf16 v[80:83], v[248:251], v[104:107], v[80:83]
    buffer_load_dwordx4 v[216:219], v7, s[36:39], s48 offen offset:0
    v_perm_b32 v254, v151, v147, s55
    v_perm_b32 v255, v159, v155, s55
    v_mfma_f32_16x16x32_bf16 v[84:87], v[248:251], v[108:111], v[84:87]
    s_waitcnt vmcnt(7)
    v_perm_b32 v224, v164, v160, s54
    v_perm_b32 v225, v172, v168, s54
    v_mfma_f32_16x16x32_bf16 v[88:91], v[252:255], v[104:107], v[88:91]
    buffer_load_dwordx4 v[220:223], v8, s[36:39], s48 offen offset:0
    v_perm_b32 v226, v180, v176, s54
    v_perm_b32 v227, v188, v184, s54
    v_mfma_f32_16x16x32_bf16 v[92:95], v[252:255], v[108:111], v[92:95]
    ds_read_b128 v[104:107], v16 offset:512
    ds_read_b128 v[108:111], v16 offset:16896
    v_perm_b32 v228, v164, v160, s55
    v_perm_b32 v229, v172, v168, s55
    s_waitcnt lgkmcnt(2)
    v_mfma_f32_16x16x32_bf16 v[32:35], v[224:227], v[96:99], v[32:35]
    s_mov_b32 s48, 3145728
    buffer_load_dwordx4 v[128:131], v1, s[36:39], s48 offen offset:0
    v_perm_b32 v230, v180, v176, s55
    v_perm_b32 v231, v188, v184, s55
    v_mfma_f32_16x16x32_bf16 v[36:39], v[224:227], v[100:103], v[36:39]
    v_perm_b32 v232, v165, v161, s54
    v_perm_b32 v233, v173, v169, s54
    v_mfma_f32_16x16x32_bf16 v[40:43], v[228:231], v[96:99], v[40:43]
    buffer_load_dwordx4 v[132:135], v2, s[36:39], s48 offen offset:0
    v_perm_b32 v234, v181, v177, s54
    v_perm_b32 v235, v189, v185, s54
    v_mfma_f32_16x16x32_bf16 v[44:47], v[228:231], v[100:103], v[44:47]
    v_perm_b32 v236, v165, v161, s55
    v_perm_b32 v237, v173, v169, s55
    v_mfma_f32_16x16x32_bf16 v[48:51], v[232:235], v[96:99], v[48:51]
    buffer_load_dwordx4 v[136:139], v3, s[36:39], s48 offen offset:0
    v_perm_b32 v238, v181, v177, s55
    v_perm_b32 v239, v189, v185, s55
    v_mfma_f32_16x16x32_bf16 v[52:55], v[232:235], v[100:103], v[52:55]
    v_perm_b32 v240, v166, v162, s54
    v_perm_b32 v241, v174, v170, s54
    v_mfma_f32_16x16x32_bf16 v[56:59], v[236:239], v[96:99], v[56:59]
    buffer_load_dwordx4 v[140:143], v4, s[36:39], s48 offen offset:0
    v_perm_b32 v242, v182, v178, s54
    v_perm_b32 v243, v190, v186, s54
    v_mfma_f32_16x16x32_bf16 v[60:63], v[236:239], v[100:103], v[60:63]
    v_perm_b32 v244, v166, v162, s55
    v_perm_b32 v245, v174, v170, s55
    v_mfma_f32_16x16x32_bf16 v[64:67], v[240:243], v[96:99], v[64:67]
    buffer_load_dwordx4 v[144:147], v5, s[36:39], s48 offen offset:0
    v_perm_b32 v246, v182, v178, s55
    v_perm_b32 v247, v190, v186, s55
    v_mfma_f32_16x16x32_bf16 v[68:71], v[240:243], v[100:103], v[68:71]
    v_perm_b32 v248, v167, v163, s54
    v_perm_b32 v249, v175, v171, s54
    v_mfma_f32_16x16x32_bf16 v[72:75], v[244:247], v[96:99], v[72:75]
    buffer_load_dwordx4 v[148:151], v6, s[36:39], s48 offen offset:0
    v_perm_b32 v250, v183, v179, s54
    v_perm_b32 v251, v191, v187, s54
    v_mfma_f32_16x16x32_bf16 v[76:79], v[244:247], v[100:103], v[76:79]
    v_perm_b32 v252, v167, v163, s55
    v_perm_b32 v253, v175, v171, s55
    v_mfma_f32_16x16x32_bf16 v[80:83], v[248:251], v[96:99], v[80:83]
    buffer_load_dwordx4 v[152:155], v7, s[36:39], s48 offen offset:0
    v_perm_b32 v254, v183, v179, s55
    v_perm_b32 v255, v191, v187, s55
    v_mfma_f32_16x16x32_bf16 v[84:87], v[248:251], v[100:103], v[84:87]
    s_waitcnt vmcnt(7)
    v_perm_b32 v224, v196, v192, s54
    v_perm_b32 v225, v204, v200, s54
    v_mfma_f32_16x16x32_bf16 v[88:91], v[252:255], v[96:99], v[88:91]
    buffer_load_dwordx4 v[156:159], v8, s[36:39], s48 offen offset:0
    v_perm_b32 v226, v212, v208, s54
    v_perm_b32 v227, v220, v216, s54
    v_mfma_f32_16x16x32_bf16 v[92:95], v[252:255], v[100:103], v[92:95]
    ds_read_b128 v[96:99], v13 offset:768
    ds_read_b128 v[100:103], v13 offset:17152
    v_perm_b32 v228, v196, v192, s55
    v_perm_b32 v229, v204, v200, s55
    s_waitcnt lgkmcnt(2)
    v_mfma_f32_16x16x32_bf16 v[32:35], v[224:227], v[104:107], v[32:35]
    s_mov_b32 s48, 3407872
    buffer_load_dwordx4 v[160:163], v1, s[36:39], s48 offen offset:0
    v_perm_b32 v230, v212, v208, s55
    v_perm_b32 v231, v220, v216, s55
    v_mfma_f32_16x16x32_bf16 v[36:39], v[224:227], v[108:111], v[36:39]
    v_perm_b32 v232, v197, v193, s54
    v_perm_b32 v233, v205, v201, s54
    v_mfma_f32_16x16x32_bf16 v[40:43], v[228:231], v[104:107], v[40:43]
    buffer_load_dwordx4 v[164:167], v2, s[36:39], s48 offen offset:0
    v_perm_b32 v234, v213, v209, s54
    v_perm_b32 v235, v221, v217, s54
    v_mfma_f32_16x16x32_bf16 v[44:47], v[228:231], v[108:111], v[44:47]
    v_perm_b32 v236, v197, v193, s55
    v_perm_b32 v237, v205, v201, s55
    v_mfma_f32_16x16x32_bf16 v[48:51], v[232:235], v[104:107], v[48:51]
    buffer_load_dwordx4 v[168:171], v3, s[36:39], s48 offen offset:0
    v_perm_b32 v238, v213, v209, s55
    v_perm_b32 v239, v221, v217, s55
    v_mfma_f32_16x16x32_bf16 v[52:55], v[232:235], v[108:111], v[52:55]
    v_perm_b32 v240, v198, v194, s54
    v_perm_b32 v241, v206, v202, s54
    v_mfma_f32_16x16x32_bf16 v[56:59], v[236:239], v[104:107], v[56:59]
    buffer_load_dwordx4 v[172:175], v4, s[36:39], s48 offen offset:0
    v_perm_b32 v242, v214, v210, s54
    v_perm_b32 v243, v222, v218, s54
    v_mfma_f32_16x16x32_bf16 v[60:63], v[236:239], v[108:111], v[60:63]
    v_perm_b32 v244, v198, v194, s55
    v_perm_b32 v245, v206, v202, s55
    v_mfma_f32_16x16x32_bf16 v[64:67], v[240:243], v[104:107], v[64:67]
    buffer_load_dwordx4 v[176:179], v5, s[36:39], s48 offen offset:0
    v_perm_b32 v246, v214, v210, s55
    v_perm_b32 v247, v222, v218, s55
    v_mfma_f32_16x16x32_bf16 v[68:71], v[240:243], v[108:111], v[68:71]
    v_perm_b32 v248, v199, v195, s54
    v_perm_b32 v249, v207, v203, s54
    v_mfma_f32_16x16x32_bf16 v[72:75], v[244:247], v[104:107], v[72:75]
    buffer_load_dwordx4 v[180:183], v6, s[36:39], s48 offen offset:0
    v_perm_b32 v250, v215, v211, s54
    v_perm_b32 v251, v223, v219, s54
    v_mfma_f32_16x16x32_bf16 v[76:79], v[244:247], v[108:111], v[76:79]
    v_perm_b32 v252, v199, v195, s55
    v_perm_b32 v253, v207, v203, s55
    v_mfma_f32_16x16x32_bf16 v[80:83], v[248:251], v[104:107], v[80:83]
    buffer_load_dwordx4 v[184:187], v7, s[36:39], s48 offen offset:0
    v_perm_b32 v254, v215, v211, s55
    v_perm_b32 v255, v223, v219, s55
    v_mfma_f32_16x16x32_bf16 v[84:87], v[248:251], v[108:111], v[84:87]
    s_waitcnt vmcnt(7)
    v_perm_b32 v224, v132, v128, s54
    v_perm_b32 v225, v140, v136, s54
    v_mfma_f32_16x16x32_bf16 v[88:91], v[252:255], v[104:107], v[88:91]
    buffer_load_dwordx4 v[188:191], v8, s[36:39], s48 offen offset:0
    v_perm_b32 v226, v148, v144, s54
    v_perm_b32 v227, v156, v152, s54
    v_mfma_f32_16x16x32_bf16 v[92:95], v[252:255], v[108:111], v[92:95]
    ds_read_b128 v[104:107], v14 offset:768
    ds_read_b128 v[108:111], v14 offset:17152
    v_perm_b32 v228, v132, v128, s55
    v_perm_b32 v229, v140, v136, s55
    s_waitcnt lgkmcnt(2)
    v_mfma_f32_16x16x32_bf16 v[32:35], v[224:227], v[96:99], v[32:35]
    s_mov_b32 s48, 3670016
    buffer_load_dwordx4 v[192:195], v1, s[36:39], s48 offen offset:0
    v_perm_b32 v230, v148, v144, s55
    v_perm_b32 v231, v156, v152, s55
    v_mfma_f32_16x16x32_bf16 v[36:39], v[224:227], v[100:103], v[36:39]
    v_perm_b32 v232, v133, v129, s54
    v_perm_b32 v233, v141, v137, s54
    v_mfma_f32_16x16x32_bf16 v[40:43], v[228:231], v[96:99], v[40:43]
    buffer_load_dwordx4 v[196:199], v2, s[36:39], s48 offen offset:0
    v_perm_b32 v234, v149, v145, s54
    v_perm_b32 v235, v157, v153, s54
    v_mfma_f32_16x16x32_bf16 v[44:47], v[228:231], v[100:103], v[44:47]
    v_perm_b32 v236, v133, v129, s55
    v_perm_b32 v237, v141, v137, s55
    v_mfma_f32_16x16x32_bf16 v[48:51], v[232:235], v[96:99], v[48:51]
    buffer_load_dwordx4 v[200:203], v3, s[36:39], s48 offen offset:0
    v_perm_b32 v238, v149, v145, s55
    v_perm_b32 v239, v157, v153, s55
    v_mfma_f32_16x16x32_bf16 v[52:55], v[232:235], v[100:103], v[52:55]
    v_perm_b32 v240, v134, v130, s54
    v_perm_b32 v241, v142, v138, s54
    v_mfma_f32_16x16x32_bf16 v[56:59], v[236:239], v[96:99], v[56:59]
    buffer_load_dwordx4 v[204:207], v4, s[36:39], s48 offen offset:0
    v_perm_b32 v242, v150, v146, s54
    v_perm_b32 v243, v158, v154, s54
    v_mfma_f32_16x16x32_bf16 v[60:63], v[236:239], v[100:103], v[60:63]
    v_perm_b32 v244, v134, v130, s55
    v_perm_b32 v245, v142, v138, s55
    v_mfma_f32_16x16x32_bf16 v[64:67], v[240:243], v[96:99], v[64:67]
    buffer_load_dwordx4 v[208:211], v5, s[36:39], s48 offen offset:0
    v_perm_b32 v246, v150, v146, s55
    v_perm_b32 v247, v158, v154, s55
    v_mfma_f32_16x16x32_bf16 v[68:71], v[240:243], v[100:103], v[68:71]
    v_perm_b32 v248, v135, v131, s54
    v_perm_b32 v249, v143, v139, s54
    v_mfma_f32_16x16x32_bf16 v[72:75], v[244:247], v[96:99], v[72:75]
    buffer_load_dwordx4 v[212:215], v6, s[36:39], s48 offen offset:0
    v_perm_b32 v250, v151, v147, s54
    v_perm_b32 v251, v159, v155, s54
    v_mfma_f32_16x16x32_bf16 v[76:79], v[244:247], v[100:103], v[76:79]
    v_perm_b32 v252, v135, v131, s55
    v_perm_b32 v253, v143, v139, s55
    v_mfma_f32_16x16x32_bf16 v[80:83], v[248:251], v[96:99], v[80:83]
    buffer_load_dwordx4 v[216:219], v7, s[36:39], s48 offen offset:0
    v_perm_b32 v254, v151, v147, s55
    v_perm_b32 v255, v159, v155, s55
    v_mfma_f32_16x16x32_bf16 v[84:87], v[248:251], v[100:103], v[84:87]
    s_waitcnt vmcnt(7)
    v_perm_b32 v224, v164, v160, s54
    v_perm_b32 v225, v172, v168, s54
    v_mfma_f32_16x16x32_bf16 v[88:91], v[252:255], v[96:99], v[88:91]
    buffer_load_dwordx4 v[220:223], v8, s[36:39], s48 offen offset:0
    v_perm_b32 v226, v180, v176, s54
    v_perm_b32 v227, v188, v184, s54
    v_mfma_f32_16x16x32_bf16 v[92:95], v[252:255], v[100:103], v[92:95]
    s_barrier
    ds_read_b128 v[96:99], v15 offset:768
    ds_read_b128 v[100:103], v15 offset:17152
    v_perm_b32 v228, v164, v160, s55
    v_perm_b32 v229, v172, v168, s55
    s_waitcnt lgkmcnt(2)
    v_mfma_f32_16x16x32_bf16 v[32:35], v[224:227], v[104:107], v[32:35]
    s_mov_b32 s48, 3932160
    buffer_load_dwordx4 v[128:131], v1, s[36:39], s48 offen offset:0
    v_perm_b32 v230, v180, v176, s55
    v_perm_b32 v231, v188, v184, s55
    v_mfma_f32_16x16x32_bf16 v[36:39], v[224:227], v[108:111], v[36:39]
    v_perm_b32 v232, v165, v161, s54
    v_perm_b32 v233, v173, v169, s54
    v_mfma_f32_16x16x32_bf16 v[40:43], v[228:231], v[104:107], v[40:43]
    buffer_load_dwordx4 v[132:135], v2, s[36:39], s48 offen offset:0
    v_perm_b32 v234, v181, v177, s54
    v_perm_b32 v235, v189, v185, s54
    v_mfma_f32_16x16x32_bf16 v[44:47], v[228:231], v[108:111], v[44:47]
    v_perm_b32 v236, v165, v161, s55
    v_perm_b32 v237, v173, v169, s55
    v_mfma_f32_16x16x32_bf16 v[48:51], v[232:235], v[104:107], v[48:51]
    buffer_load_dwordx4 v[136:139], v3, s[36:39], s48 offen offset:0
    v_perm_b32 v238, v181, v177, s55
    v_perm_b32 v239, v189, v185, s55
    v_mfma_f32_16x16x32_bf16 v[52:55], v[232:235], v[108:111], v[52:55]
    v_perm_b32 v240, v166, v162, s54
    v_perm_b32 v241, v174, v170, s54
    v_mfma_f32_16x16x32_bf16 v[56:59], v[236:239], v[104:107], v[56:59]
    buffer_load_dwordx4 v[140:143], v4, s[36:39], s48 offen offset:0
    v_perm_b32 v242, v182, v178, s54
    v_perm_b32 v243, v190, v186, s54
    v_mfma_f32_16x16x32_bf16 v[60:63], v[236:239], v[108:111], v[60:63]
    v_perm_b32 v244, v166, v162, s55
    v_perm_b32 v245, v174, v170, s55
    v_mfma_f32_16x16x32_bf16 v[64:67], v[240:243], v[104:107], v[64:67]
    buffer_load_dwordx4 v[144:147], v5, s[36:39], s48 offen offset:0
    v_perm_b32 v246, v182, v178, s55
    v_perm_b32 v247, v190, v186, s55
    v_mfma_f32_16x16x32_bf16 v[68:71], v[240:243], v[108:111], v[68:71]
    v_perm_b32 v248, v167, v163, s54
    v_perm_b32 v249, v175, v171, s54
    v_mfma_f32_16x16x32_bf16 v[72:75], v[244:247], v[104:107], v[72:75]
    buffer_load_dwordx4 v[148:151], v6, s[36:39], s48 offen offset:0
    v_perm_b32 v250, v183, v179, s54
    v_perm_b32 v251, v191, v187, s54
    v_mfma_f32_16x16x32_bf16 v[76:79], v[244:247], v[108:111], v[76:79]
    v_perm_b32 v252, v167, v163, s55
    v_perm_b32 v253, v175, v171, s55
    v_mfma_f32_16x16x32_bf16 v[80:83], v[248:251], v[104:107], v[80:83]
    buffer_load_dwordx4 v[152:155], v7, s[36:39], s48 offen offset:0
    v_perm_b32 v254, v183, v179, s55
    v_perm_b32 v255, v191, v187, s55
    v_mfma_f32_16x16x32_bf16 v[84:87], v[248:251], v[108:111], v[84:87]
    s_waitcnt vmcnt(7)
    v_perm_b32 v224, v196, v192, s54
    v_perm_b32 v225, v204, v200, s54
    v_mfma_f32_16x16x32_bf16 v[88:91], v[252:255], v[104:107], v[88:91]
    buffer_load_dwordx4 v[156:159], v8, s[36:39], s48 offen offset:0
    v_perm_b32 v226, v212, v208, s54
    v_perm_b32 v227, v220, v216, s54
    v_mfma_f32_16x16x32_bf16 v[92:95], v[252:255], v[108:111], v[92:95]
    ds_read_b128 v[104:107], v16 offset:768
    ds_read_b128 v[108:111], v16 offset:17152
    v_perm_b32 v228, v196, v192, s55
    v_perm_b32 v229, v204, v200, s55
    s_waitcnt lgkmcnt(2)
    v_mfma_f32_16x16x32_bf16 v[32:35], v[224:227], v[96:99], v[32:35]
    v_perm_b32 v230, v212, v208, s55
    v_perm_b32 v231, v220, v216, s55
    v_mfma_f32_16x16x32_bf16 v[36:39], v[224:227], v[100:103], v[36:39]
    v_perm_b32 v232, v197, v193, s54
    v_perm_b32 v233, v205, v201, s54
    v_mfma_f32_16x16x32_bf16 v[40:43], v[228:231], v[96:99], v[40:43]
    v_perm_b32 v234, v213, v209, s54
    v_perm_b32 v235, v221, v217, s54
    v_mfma_f32_16x16x32_bf16 v[44:47], v[228:231], v[100:103], v[44:47]
    v_perm_b32 v236, v197, v193, s55
    v_perm_b32 v237, v205, v201, s55
    v_mfma_f32_16x16x32_bf16 v[48:51], v[232:235], v[96:99], v[48:51]
    v_perm_b32 v238, v213, v209, s55
    v_perm_b32 v239, v221, v217, s55
    v_mfma_f32_16x16x32_bf16 v[52:55], v[232:235], v[100:103], v[52:55]
    v_perm_b32 v240, v198, v194, s54
    v_perm_b32 v241, v206, v202, s54
    v_mfma_f32_16x16x32_bf16 v[56:59], v[236:239], v[96:99], v[56:59]
    v_perm_b32 v242, v214, v210, s54
    v_perm_b32 v243, v222, v218, s54
    v_mfma_f32_16x16x32_bf16 v[60:63], v[236:239], v[100:103], v[60:63]
    v_perm_b32 v244, v198, v194, s55
    v_perm_b32 v245, v206, v202, s55
    v_mfma_f32_16x16x32_bf16 v[64:67], v[240:243], v[96:99], v[64:67]
    v_perm_b32 v246, v214, v210, s55
    v_perm_b32 v247, v222, v218, s55
    v_mfma_f32_16x16x32_bf16 v[68:71], v[240:243], v[100:103], v[68:71]
    v_perm_b32 v248, v199, v195, s54
    v_perm_b32 v249, v207, v203, s54
    v_mfma_f32_16x16x32_bf16 v[72:75], v[244:247], v[96:99], v[72:75]
    v_perm_b32 v250, v215, v211, s54
    v_perm_b32 v251, v223, v219, s54
    v_mfma_f32_16x16x32_bf16 v[76:79], v[244:247], v[100:103], v[76:79]
    v_perm_b32 v252, v199, v195, s55
    v_perm_b32 v253, v207, v203, s55
    v_mfma_f32_16x16x32_bf16 v[80:83], v[248:251], v[96:99], v[80:83]
    v_perm_b32 v254, v215, v211, s55
    v_perm_b32 v255, v223, v219, s55
    v_mfma_f32_16x16x32_bf16 v[84:87], v[248:251], v[100:103], v[84:87]
    s_waitcnt vmcnt(0)
    v_perm_b32 v224, v132, v128, s54
    v_perm_b32 v225, v140, v136, s54
    v_mfma_f32_16x16x32_bf16 v[88:91], v[252:255], v[96:99], v[88:91]
    v_perm_b32 v226, v148, v144, s54
    v_perm_b32 v227, v156, v152, s54
    v_mfma_f32_16x16x32_bf16 v[92:95], v[252:255], v[100:103], v[92:95]
    v_perm_b32 v228, v132, v128, s55
    v_perm_b32 v229, v140, v136, s55
    s_waitcnt lgkmcnt(0)
    v_mfma_f32_16x16x32_bf16 v[32:35], v[224:227], v[104:107], v[32:35]
    v_perm_b32 v230, v148, v144, s55
    v_perm_b32 v231, v156, v152, s55
    v_mfma_f32_16x16x32_bf16 v[36:39], v[224:227], v[108:111], v[36:39]
    v_perm_b32 v232, v133, v129, s54
    v_perm_b32 v233, v141, v137, s54
    v_mfma_f32_16x16x32_bf16 v[40:43], v[228:231], v[104:107], v[40:43]
    v_perm_b32 v234, v149, v145, s54
    v_perm_b32 v235, v157, v153, s54
    v_mfma_f32_16x16x32_bf16 v[44:47], v[228:231], v[108:111], v[44:47]
    v_perm_b32 v236, v133, v129, s55
    v_perm_b32 v237, v141, v137, s55
    v_mfma_f32_16x16x32_bf16 v[48:51], v[232:235], v[104:107], v[48:51]
    v_perm_b32 v238, v149, v145, s55
    v_perm_b32 v239, v157, v153, s55
    v_mfma_f32_16x16x32_bf16 v[52:55], v[232:235], v[108:111], v[52:55]
    v_perm_b32 v240, v134, v130, s54
    v_perm_b32 v241, v142, v138, s54
    v_mfma_f32_16x16x32_bf16 v[56:59], v[236:239], v[104:107], v[56:59]
    v_perm_b32 v242, v150, v146, s54
    v_perm_b32 v243, v158, v154, s54
    v_mfma_f32_16x16x32_bf16 v[60:63], v[236:239], v[108:111], v[60:63]
    v_perm_b32 v244, v134, v130, s55
    v_perm_b32 v245, v142, v138, s55
    v_mfma_f32_16x16x32_bf16 v[64:67], v[240:243], v[104:107], v[64:67]
    v_perm_b32 v246, v150, v146, s55
    v_perm_b32 v247, v158, v154, s55
    v_mfma_f32_16x16x32_bf16 v[68:71], v[240:243], v[108:111], v[68:71]
    v_perm_b32 v248, v135, v131, s54
    v_perm_b32 v249, v143, v139, s54
    v_mfma_f32_16x16x32_bf16 v[72:75], v[244:247], v[104:107], v[72:75]
    v_perm_b32 v250, v151, v147, s54
    v_perm_b32 v251, v159, v155, s54
    v_mfma_f32_16x16x32_bf16 v[76:79], v[244:247], v[108:111], v[76:79]
    v_perm_b32 v252, v135, v131, s55
    v_perm_b32 v253, v143, v139, s55
    v_mfma_f32_16x16x32_bf16 v[80:83], v[248:251], v[104:107], v[80:83]
    v_perm_b32 v254, v151, v147, s55
    v_perm_b32 v255, v159, v155, s55
    v_mfma_f32_16x16x32_bf16 v[84:87], v[248:251], v[108:111], v[84:87]
    s_nop 0
    v_mfma_f32_16x16x32_bf16 v[88:91], v[252:255], v[104:107], v[88:91]
    v_mfma_f32_16x16x32_bf16 v[92:95], v[252:255], v[108:111], v[92:95]
    v_mbcnt_lo_u32_b32 v28, -1, 0
    v_mbcnt_hi_u32_b32 v28, -1, v28
    v_lshrrev_b32 v30, 5, v28
    v_bfe_u32 v29, v28, 2, 2
    v_bfe_u32 v31, v28, 4, 1
    v_lshlrev_b32 v31, 2, v31
    v_and_b32 v24, 1, v28
    v_lshlrev_b32 v24, 1, v24
    v_or_b32 v31, v31, v24
    v_bfe_u32 v24, v28, 1, 1
    v_or_b32 v31, v31, v24
    v_lshlrev_b32 v31, 3, v31
    v_lshlrev_b32 v24, 2, v30
    v_add_u32 v24, v24, v29
    v_lshlrev_b32 v24, 8, v24
    v_add_u32 v24, v24, v31
    v_xor_b32 v25, 0, v29
    v_lshlrev_b32 v25, 6, v25
    v_add_u32 v9, v24, v25
    v_xor_b32 v25, 1, v29
    v_lshlrev_b32 v25, 6, v25
    v_add_u32 v10, v24, v25
    v_xor_b32 v25, 2, v29
    v_lshlrev_b32 v25, 6, v25
    v_add_u32 v11, v24, v25
    v_xor_b32 v25, 3, v29
    v_lshlrev_b32 v25, 6, v25
    v_add_u32 v12, v24, v25
    v_and_b32 v24, 15, v28
    v_lshlrev_b32 v25, 3, v30
    v_xor_b32 v24, v24, v25
    v_lshlrev_b32 v24, 4, v24
    v_and_b32 v25, 31, v28
    v_lshlrev_b32 v25, 8, v25
    v_xor_b32 v1, 0, v24
    v_add_u32 v1, v1, v25
    v_xor_b32 v2, 16, v24
    v_add_u32 v2, v2, v25
    v_xor_b32 v3, 32, v24
    v_add_u32 v3, v3, v25
    v_xor_b32 v4, 48, v24
    v_add_u32 v4, v4, v25
    v_xor_b32 v5, 64, v24
    v_add_u32 v5, v5, v25
    v_xor_b32 v6, 80, v24
    v_add_u32 v6, v6, v25
    v_xor_b32 v7, 96, v24
    v_add_u32 v7, v7, v25
    v_xor_b32 v8, 112, v24
    v_add_u32 v8, v8, v25
    v_and_b32 v24, 15, v28
    v_lshlrev_b32 v24, 4, v24
    v_lshrrev_b32 v25, 4, v28
    v_lshlrev_b32 v25, 13, v25
    v_add_u32 v17, v24, v25
    v_add_u32 v18, 4096, v17
    v_cvt_pk_bf16_f32 v128, v32, v40
    v_cvt_pk_bf16_f32 v144, v36, v44
    v_cvt_pk_bf16_f32 v129, v48, v56
    v_cvt_pk_bf16_f32 v145, v52, v60
    v_cvt_pk_bf16_f32 v130, v64, v72
    v_cvt_pk_bf16_f32 v146, v68, v76
    v_cvt_pk_bf16_f32 v131, v80, v88
    v_cvt_pk_bf16_f32 v147, v84, v92
    v_cvt_pk_bf16_f32 v132, v33, v41
    v_cvt_pk_bf16_f32 v148, v37, v45
    v_cvt_pk_bf16_f32 v133, v49, v57
    v_cvt_pk_bf16_f32 v149, v53, v61
    v_cvt_pk_bf16_f32 v134, v65, v73
    v_cvt_pk_bf16_f32 v150, v69, v77
    v_cvt_pk_bf16_f32 v135, v81, v89
    v_cvt_pk_bf16_f32 v151, v85, v93
    v_cvt_pk_bf16_f32 v136, v34, v42
    v_cvt_pk_bf16_f32 v152, v38, v46
    v_cvt_pk_bf16_f32 v137, v50, v58
    v_cvt_pk_bf16_f32 v153, v54, v62
    v_cvt_pk_bf16_f32 v138, v66, v74
    v_cvt_pk_bf16_f32 v154, v70, v78
    v_cvt_pk_bf16_f32 v139, v82, v90
    v_cvt_pk_bf16_f32 v155, v86, v94
    v_cvt_pk_bf16_f32 v140, v35, v43
    v_cvt_pk_bf16_f32 v156, v39, v47
    v_cvt_pk_bf16_f32 v141, v51, v59
    v_cvt_pk_bf16_f32 v157, v55, v63
    v_cvt_pk_bf16_f32 v142, v67, v75
    v_cvt_pk_bf16_f32 v158, v71, v79
    v_cvt_pk_bf16_f32 v143, v83, v91
    v_cvt_pk_bf16_f32 v159, v87, v95
    v_permlane16_swap_b32 v128, v144
    v_permlane16_swap_b32 v129, v145
    v_permlane16_swap_b32 v130, v146
    v_permlane16_swap_b32 v131, v147
    v_permlane16_swap_b32 v132, v148
    v_permlane16_swap_b32 v133, v149
    v_permlane16_swap_b32 v134, v150
    v_permlane16_swap_b32 v135, v151
    v_permlane16_swap_b32 v136, v152
    v_permlane16_swap_b32 v137, v153
    v_permlane16_swap_b32 v138, v154
    v_permlane16_swap_b32 v139, v155
    v_permlane16_swap_b32 v140, v156
    v_permlane16_swap_b32 v141, v157
    v_permlane16_swap_b32 v142, v158
    v_permlane16_swap_b32 v143, v159
    s_barrier
    ds_read_b128 v[96:99], v1 offset:0
    ds_read_b128 v[100:103], v1 offset:8192
    ds_read_b128 v[104:107], v2 offset:0
    ds_read_b128 v[108:111], v2 offset:8192
    ds_read_b128 v[112:115], v3 offset:0
    ds_read_b128 v[116:119], v3 offset:8192
    ds_read_b128 v[120:123], v4 offset:0
    ds_read_b128 v[124:127], v4 offset:8192
    s_waitcnt lgkmcnt(6)
    v_mfma_f32_32x32x16_bf16 v[160:175], v[96:99], v[128:131], 0
    v_mfma_f32_32x32x16_bf16 v[176:191], v[100:103], v[128:131], 0
    ds_read_b128 v[96:99], v5 offset:0
    ds_read_b128 v[100:103], v5 offset:8192
    s_waitcnt lgkmcnt(6)
    v_mfma_f32_32x32x16_bf16 v[160:175], v[104:107], v[132:135], v[160:175]
    v_mfma_f32_32x32x16_bf16 v[176:191], v[108:111], v[132:135], v[176:191]
    ds_read_b128 v[104:107], v6 offset:0
    ds_read_b128 v[108:111], v6 offset:8192
    s_waitcnt lgkmcnt(6)
    v_mfma_f32_32x32x16_bf16 v[160:175], v[112:115], v[136:139], v[160:175]
    v_mfma_f32_32x32x16_bf16 v[176:191], v[116:119], v[136:139], v[176:191]
    ds_read_b128 v[112:115], v7 offset:0
    ds_read_b128 v[116:119], v7 offset:8192
    s_waitcnt lgkmcnt(6)
    v_mfma_f32_32x32x16_bf16 v[160:175], v[120:123], v[140:143], v[160:175]
    v_mfma_f32_32x32x16_bf16 v[176:191], v[124:127], v[140:143], v[176:191]
    ds_read_b128 v[120:123], v8 offset:0
    ds_read_b128 v[124:127], v8 offset:8192
    s_waitcnt lgkmcnt(6)
    v_mfma_f32_32x32x16_bf16 v[160:175], v[96:99], v[144:147], v[160:175]
    v_mfma_f32_32x32x16_bf16 v[176:191], v[100:103], v[144:147], v[176:191]
    s_waitcnt lgkmcnt(4)
    v_mfma_f32_32x32x16_bf16 v[160:175], v[104:107], v[148:151], v[160:175]
    v_mfma_f32_32x32x16_bf16 v[176:191], v[108:111], v[148:151], v[176:191]
    s_waitcnt lgkmcnt(2)
    v_mfma_f32_32x32x16_bf16 v[160:175], v[112:115], v[152:155], v[160:175]
    v_mfma_f32_32x32x16_bf16 v[176:191], v[116:119], v[152:155], v[176:191]
    s_waitcnt lgkmcnt(0)
    v_mfma_f32_32x32x16_bf16 v[160:175], v[120:123], v[156:159], v[160:175]
    v_mfma_f32_32x32x16_bf16 v[176:191], v[124:127], v[156:159], v[176:191]
    s_waitcnt lgkmcnt(0)
    s_barrier
    ds_read_b128 v[96:99], v1 offset:16384
    ds_read_b128 v[100:103], v1 offset:24576
    ds_read_b128 v[104:107], v2 offset:16384
    ds_read_b128 v[108:111], v2 offset:24576
    ds_read_b128 v[112:115], v3 offset:16384
    ds_read_b128 v[116:119], v3 offset:24576
    ds_read_b128 v[120:123], v4 offset:16384
    ds_read_b128 v[124:127], v4 offset:24576
    s_nop 0
    v_max3_f32 v24, v160, v161, v162
    v_max3_f32 v25, v163, v164, v165
    v_max3_f32 v24, v24, v166, v167
    v_max3_f32 v25, v25, v168, v169
    v_max3_f32 v24, v24, v170, v171
    v_max3_f32 v25, v25, v172, v173
    v_max3_f32 v24, v24, v174, v175
    v_max3_f32 v25, v25, v176, v177
    v_max3_f32 v24, v24, v178, v179
    v_max3_f32 v25, v25, v180, v181
    v_max3_f32 v24, v24, v182, v183
    v_max3_f32 v25, v25, v184, v185
    v_max3_f32 v24, v24, v186, v187
    v_max3_f32 v25, v25, v188, v189
    v_max3_f32 v24, v24, v190, v191
    v_max_f32 v24, v24, v25
    v_mov_b32 v25, v24
    s_nop 1
    v_permlane32_swap_b32 v24, v25
    v_max_f32 v20, v24, v25
    v_mul_f32 v23, s50, v20
    v_fma_f32 v160, v160, s50, -v23
    v_fma_f32 v161, v161, s50, -v23
    v_fma_f32 v162, v162, s50, -v23
    v_fma_f32 v163, v163, s50, -v23
    v_fma_f32 v164, v164, s50, -v23
    v_fma_f32 v165, v165, s50, -v23
    v_fma_f32 v166, v166, s50, -v23
    v_fma_f32 v167, v167, s50, -v23
    v_exp_f32 v160, v160
    s_waitcnt lgkmcnt(6)
    v_mfma_f32_32x32x16_bf16 v[192:207], v[96:99], v[128:131], 0
    v_exp_f32 v161, v161
    v_exp_f32 v162, v162
    v_exp_f32 v163, v163
    v_exp_f32 v164, v164
    v_exp_f32 v165, v165
    v_mfma_f32_32x32x16_bf16 v[208:223], v[100:103], v[128:131], 0
    ds_read_b128 v[96:99], v5 offset:16384
    ds_read_b128 v[100:103], v5 offset:24576
    v_exp_f32 v166, v166
    v_exp_f32 v167, v167
    v_mov_b32 v21, v160
    v_mov_b32 v26, v161
    v_add_f32 v21, v21, v162
    s_waitcnt lgkmcnt(6)
    v_mfma_f32_32x32x16_bf16 v[192:207], v[104:107], v[132:135], v[192:207]
    v_add_f32 v26, v26, v163
    v_add_f32 v21, v21, v164
    v_add_f32 v26, v26, v165
    v_add_f32 v21, v21, v166
    v_add_f32 v26, v26, v167
    v_cvt_pk_bf16_f32 v224, v160, v161
    v_cvt_pk_bf16_f32 v225, v162, v163
    v_cvt_pk_bf16_f32 v226, v164, v165
    v_cvt_pk_bf16_f32 v227, v166, v167
    v_mfma_f32_32x32x16_bf16 v[208:223], v[108:111], v[132:135], v[208:223]
    ds_read_b128 v[104:107], v6 offset:16384
    ds_read_b128 v[108:111], v6 offset:24576
    v_fma_f32 v168, v168, s50, -v23
    v_fma_f32 v169, v169, s50, -v23
    v_fma_f32 v170, v170, s50, -v23
    v_fma_f32 v171, v171, s50, -v23
    v_fma_f32 v172, v172, s50, -v23
    v_fma_f32 v173, v173, s50, -v23
    v_fma_f32 v174, v174, s50, -v23
    v_fma_f32 v175, v175, s50, -v23
    s_waitcnt lgkmcnt(6)
    v_mfma_f32_32x32x16_bf16 v[192:207], v[112:115], v[136:139], v[192:207]
    v_exp_f32 v168, v168
    v_exp_f32 v169, v169
    v_exp_f32 v170, v170
    v_exp_f32 v171, v171
    v_exp_f32 v172, v172
    v_mfma_f32_32x32x16_bf16 v[208:223], v[116:119], v[136:139], v[208:223]
    ds_read_b128 v[112:115], v7 offset:16384
    ds_read_b128 v[116:119], v7 offset:24576
    v_exp_f32 v173, v173
    v_exp_f32 v174, v174
    v_exp_f32 v175, v175
    v_add_f32 v21, v21, v168
    s_waitcnt lgkmcnt(6)
    v_mfma_f32_32x32x16_bf16 v[192:207], v[120:123], v[140:143], v[192:207]
    v_add_f32 v26, v26, v169
    v_add_f32 v21, v21, v170
    v_add_f32 v26, v26, v171
    v_add_f32 v21, v21, v172
    v_add_f32 v26, v26, v173
    v_add_f32 v21, v21, v174
    v_add_f32 v26, v26, v175
    v_cvt_pk_bf16_f32 v228, v168, v169
    v_cvt_pk_bf16_f32 v229, v170, v171
    v_mfma_f32_32x32x16_bf16 v[208:223], v[124:127], v[140:143], v[208:223]
    ds_read_b128 v[120:123], v8 offset:16384
    ds_read_b128 v[124:127], v8 offset:24576
    v_cvt_pk_bf16_f32 v230, v172, v173
    v_cvt_pk_bf16_f32 v231, v174, v175
    v_fma_f32 v176, v176, s50, -v23
    v_fma_f32 v177, v177, s50, -v23
    v_fma_f32 v178, v178, s50, -v23
    v_fma_f32 v179, v179, s50, -v23
    v_fma_f32 v180, v180, s50, -v23
    v_fma_f32 v181, v181, s50, -v23
    s_waitcnt lgkmcnt(6)
    v_mfma_f32_32x32x16_bf16 v[192:207], v[96:99], v[144:147], v[192:207]
    v_fma_f32 v182, v182, s50, -v23
    v_fma_f32 v183, v183, s50, -v23
    v_exp_f32 v176, v176
    v_exp_f32 v177, v177
    v_exp_f32 v178, v178
    v_mfma_f32_32x32x16_bf16 v[208:223], v[100:103], v[144:147], v[208:223]
    v_exp_f32 v179, v179
    v_exp_f32 v180, v180
    v_exp_f32 v181, v181
    v_exp_f32 v182, v182
    v_exp_f32 v183, v183
    s_waitcnt lgkmcnt(4)
    v_mfma_f32_32x32x16_bf16 v[192:207], v[104:107], v[148:151], v[192:207]
    v_add_f32 v21, v21, v176
    v_add_f32 v26, v26, v177
    v_add_f32 v21, v21, v178
    v_add_f32 v26, v26, v179
    v_add_f32 v21, v21, v180
    v_add_f32 v26, v26, v181
    v_add_f32 v21, v21, v182
    v_mfma_f32_32x32x16_bf16 v[208:223], v[108:111], v[148:151], v[208:223]
    v_add_f32 v26, v26, v183
    v_cvt_pk_bf16_f32 v232, v176, v177
    v_cvt_pk_bf16_f32 v233, v178, v179
    v_cvt_pk_bf16_f32 v234, v180, v181
    v_cvt_pk_bf16_f32 v235, v182, v183
    v_fma_f32 v184, v184, s50, -v23
    v_fma_f32 v185, v185, s50, -v23
    v_fma_f32 v186, v186, s50, -v23
    v_fma_f32 v187, v187, s50, -v23
    s_waitcnt lgkmcnt(2)
    v_mfma_f32_32x32x16_bf16 v[192:207], v[112:115], v[152:155], v[192:207]
    v_fma_f32 v188, v188, s50, -v23
    v_fma_f32 v189, v189, s50, -v23
    v_fma_f32 v190, v190, s50, -v23
    v_fma_f32 v191, v191, s50, -v23
    v_exp_f32 v184, v184
    v_exp_f32 v185, v185
    v_mfma_f32_32x32x16_bf16 v[208:223], v[116:119], v[152:155], v[208:223]
    v_exp_f32 v186, v186
    v_exp_f32 v187, v187
    v_exp_f32 v188, v188
    v_exp_f32 v189, v189
    v_exp_f32 v190, v190
    s_waitcnt lgkmcnt(0)
    v_mfma_f32_32x32x16_bf16 v[192:207], v[120:123], v[156:159], v[192:207]
    v_exp_f32 v191, v191
    v_add_f32 v21, v21, v184
    v_add_f32 v26, v26, v185
    v_add_f32 v21, v21, v186
    v_add_f32 v26, v26, v187
    v_add_f32 v21, v21, v188
    v_mfma_f32_32x32x16_bf16 v[208:223], v[124:127], v[156:159], v[208:223]
    v_add_f32 v26, v26, v189
    v_add_f32 v21, v21, v190
    v_add_f32 v26, v26, v191
    v_cvt_pk_bf16_f32 v236, v184, v185
    v_cvt_pk_bf16_f32 v237, v186, v187
    v_cvt_pk_bf16_f32 v238, v188, v189
    v_cvt_pk_bf16_f32 v239, v190, v191
    v_add_f32 v21, v21, v26
    s_waitcnt lgkmcnt(0)
    s_barrier
    ds_read_b64_tr_b16 v[96:97], v9 offset:32768
    ds_read_b64_tr_b16 v[98:99], v9 offset:34816
    ds_read_b64_tr_b16 v[100:101], v10 offset:32768
    ds_read_b64_tr_b16 v[102:103], v10 offset:34816
    ds_read_b64_tr_b16 v[104:105], v11 offset:32768
    ds_read_b64_tr_b16 v[106:107], v11 offset:34816
    ds_read_b64_tr_b16 v[108:109], v12 offset:32768
    ds_read_b64_tr_b16 v[110:111], v12 offset:34816
    ds_read_b64_tr_b16 v[112:113], v9 offset:36864
    ds_read_b64_tr_b16 v[114:115], v9 offset:38912
    ds_read_b64_tr_b16 v[116:117], v10 offset:36864
    ds_read_b64_tr_b16 v[118:119], v10 offset:38912
    v_max3_f32 v24, v192, v193, v194
    v_max3_f32 v25, v195, v196, v197
    v_max3_f32 v24, v24, v198, v199
    v_max3_f32 v25, v25, v200, v201
    v_max3_f32 v24, v24, v202, v203
    v_max3_f32 v25, v25, v204, v205
    v_max3_f32 v24, v24, v206, v207
    v_max3_f32 v25, v25, v208, v209
    v_max3_f32 v24, v24, v210, v211
    v_max3_f32 v25, v25, v212, v213
    v_max3_f32 v24, v24, v214, v215
    v_max3_f32 v25, v25, v216, v217
    v_max3_f32 v24, v24, v218, v219
    v_max3_f32 v25, v25, v220, v221
    v_max3_f32 v24, v24, v222, v223
    v_max_f32 v24, v24, v25
    v_mov_b32 v25, v24
    s_nop 1
    v_permlane32_swap_b32 v24, v25
    v_max3_f32 v24, v24, v25, v20
    v_sub_f32 v25, v20, v24
    v_mul_f32 v25, s50, v25
    v_exp_f32 v22, v25
    v_mov_b32 v20, v24
    v_mul_f32 v23, s50, v20
    v_fma_f32 v192, v192, s50, -v23
    v_fma_f32 v193, v193, s50, -v23
    v_fma_f32 v194, v194, s50, -v23
    v_fma_f32 v195, v195, s50, -v23
    v_fma_f32 v196, v196, s50, -v23
    s_waitcnt lgkmcnt(8)
    v_mfma_f32_32x32x16_bf16 v[32:47], v[96:99], v[224:227], 0
    v_fma_f32 v197, v197, s50, -v23
    v_fma_f32 v198, v198, s50, -v23
    v_fma_f32 v199, v199, s50, -v23
    v_exp_f32 v192, v192
    v_mfma_f32_32x32x16_bf16 v[48:63], v[100:103], v[224:227], 0
    ds_read_b64_tr_b16 v[120:121], v11 offset:36864
    ds_read_b64_tr_b16 v[122:123], v11 offset:38912
    ds_read_b64_tr_b16 v[124:125], v12 offset:36864
    ds_read_b64_tr_b16 v[126:127], v12 offset:38912
    v_exp_f32 v193, v193
    v_exp_f32 v194, v194
    v_exp_f32 v195, v195
    s_waitcnt lgkmcnt(8)
    v_mfma_f32_32x32x16_bf16 v[64:79], v[104:107], v[224:227], 0
    v_exp_f32 v196, v196
    v_exp_f32 v197, v197
    v_mfma_f32_32x32x16_bf16 v[80:95], v[108:111], v[224:227], 0
    ds_read_b64_tr_b16 v[96:97], v9 offset:40960
    ds_read_b64_tr_b16 v[98:99], v9 offset:43008
    ds_read_b64_tr_b16 v[100:101], v10 offset:40960
    ds_read_b64_tr_b16 v[102:103], v10 offset:43008
    v_exp_f32 v198, v198
    v_exp_f32 v199, v199
    v_fma_f32 v21, v21, v22, v192
    s_waitcnt lgkmcnt(8)
    v_mfma_f32_32x32x16_bf16 v[32:47], v[112:115], v[228:231], v[32:47]
    v_mov_b32 v26, v193
    v_add_f32 v21, v21, v194
    v_add_f32 v26, v26, v195
    v_add_f32 v21, v21, v196
    v_add_f32 v26, v26, v197
    v_mfma_f32_32x32x16_bf16 v[48:63], v[116:119], v[228:231], v[48:63]
    ds_read_b64_tr_b16 v[104:105], v11 offset:40960
    ds_read_b64_tr_b16 v[106:107], v11 offset:43008
    ds_read_b64_tr_b16 v[108:109], v12 offset:40960
    ds_read_b64_tr_b16 v[110:111], v12 offset:43008
    v_add_f32 v21, v21, v198
    v_add_f32 v26, v26, v199
    v_cvt_pk_bf16_f32 v240, v192, v193
    v_cvt_pk_bf16_f32 v241, v194, v195
    v_cvt_pk_bf16_f32 v242, v196, v197
    s_waitcnt lgkmcnt(8)
    v_mfma_f32_32x32x16_bf16 v[64:79], v[120:123], v[228:231], v[64:79]
    v_cvt_pk_bf16_f32 v243, v198, v199
    v_fma_f32 v200, v200, s50, -v23
    v_fma_f32 v201, v201, s50, -v23
    v_fma_f32 v202, v202, s50, -v23
    v_fma_f32 v203, v203, s50, -v23
    v_mfma_f32_32x32x16_bf16 v[80:95], v[124:127], v[228:231], v[80:95]
    ds_read_b64_tr_b16 v[112:113], v9 offset:45056
    ds_read_b64_tr_b16 v[114:115], v9 offset:47104
    ds_read_b64_tr_b16 v[116:117], v10 offset:45056
    ds_read_b64_tr_b16 v[118:119], v10 offset:47104
    v_fma_f32 v204, v204, s50, -v23
    v_fma_f32 v205, v205, s50, -v23
    v_fma_f32 v206, v206, s50, -v23
    v_fma_f32 v207, v207, s50, -v23
    v_exp_f32 v200, v200
    s_waitcnt lgkmcnt(8)
    v_mfma_f32_32x32x16_bf16 v[32:47], v[96:99], v[232:235], v[32:47]
    v_exp_f32 v201, v201
    v_exp_f32 v202, v202
    v_mfma_f32_32x32x16_bf16 v[48:63], v[100:103], v[232:235], v[48:63]
    ds_read_b64_tr_b16 v[120:121], v11 offset:45056
    ds_read_b64_tr_b16 v[122:123], v11 offset:47104
    ds_read_b64_tr_b16 v[124:125], v12 offset:45056
    ds_read_b64_tr_b16 v[126:127], v12 offset:47104
    v_exp_f32 v203, v203
    v_exp_f32 v204, v204
    v_exp_f32 v205, v205
    s_waitcnt lgkmcnt(8)
    v_mfma_f32_32x32x16_bf16 v[64:79], v[104:107], v[232:235], v[64:79]
    v_exp_f32 v206, v206
    v_exp_f32 v207, v207
    v_mfma_f32_32x32x16_bf16 v[80:95], v[108:111], v[232:235], v[80:95]
    v_add_f32 v21, v21, v200
    v_add_f32 v26, v26, v201
    v_add_f32 v21, v21, v202
    v_add_f32 v26, v26, v203
    v_add_f32 v21, v21, v204
    s_waitcnt lgkmcnt(4)
    v_mfma_f32_32x32x16_bf16 v[32:47], v[112:115], v[236:239], v[32:47]
    v_add_f32 v26, v26, v205
    v_add_f32 v21, v21, v206
    v_add_f32 v26, v26, v207
    v_cvt_pk_bf16_f32 v244, v200, v201
    v_cvt_pk_bf16_f32 v245, v202, v203
    v_mfma_f32_32x32x16_bf16 v[48:63], v[116:119], v[236:239], v[48:63]
    v_cvt_pk_bf16_f32 v246, v204, v205
    v_cvt_pk_bf16_f32 v247, v206, v207
    v_fma_f32 v208, v208, s50, -v23
    v_fma_f32 v209, v209, s50, -v23
    v_fma_f32 v210, v210, s50, -v23
    s_waitcnt lgkmcnt(0)
    v_mfma_f32_32x32x16_bf16 v[64:79], v[120:123], v[236:239], v[64:79]
    v_fma_f32 v211, v211, s50, -v23
    v_fma_f32 v212, v212, s50, -v23
    v_fma_f32 v213, v213, s50, -v23
    v_fma_f32 v214, v214, s50, -v23
    v_fma_f32 v215, v215, s50, -v23
    v_mfma_f32_32x32x16_bf16 v[80:95], v[124:127], v[236:239], v[80:95]
    v_exp_f32 v208, v208
    v_exp_f32 v209, v209
    s_waitcnt lgkmcnt(0)
    s_barrier
    ds_read_b128 v[96:99], v1 offset:49152
    ds_read_b128 v[100:103], v1 offset:57344
    ds_read_b128 v[104:107], v2 offset:49152
    ds_read_b128 v[108:111], v2 offset:57344
    ds_read_b128 v[112:115], v3 offset:49152
    ds_read_b128 v[116:119], v3 offset:57344
    ds_read_b128 v[120:123], v4 offset:49152
    ds_read_b128 v[124:127], v4 offset:57344
    v_mul_f32 v32, v22, v32
    v_mul_f32 v33, v22, v33
    v_mul_f32 v34, v22, v34
    v_mul_f32 v35, v22, v35
    v_mul_f32 v36, v22, v36
    v_mul_f32 v37, v22, v37
    v_mul_f32 v38, v22, v38
    v_mul_f32 v39, v22, v39
    v_mul_f32 v40, v22, v40
    v_mul_f32 v41, v22, v41
    v_mul_f32 v42, v22, v42
    v_mul_f32 v43, v22, v43
    v_mul_f32 v44, v22, v44
    v_mul_f32 v45, v22, v45
    v_mul_f32 v46, v22, v46
    v_mul_f32 v47, v22, v47
    v_mul_f32 v48, v22, v48
    v_mul_f32 v49, v22, v49
    v_mul_f32 v50, v22, v50
    v_mul_f32 v51, v22, v51
    v_mul_f32 v52, v22, v52
    v_mul_f32 v53, v22, v53
    v_mul_f32 v54, v22, v54
    v_mul_f32 v55, v22, v55
    v_mul_f32 v56, v22, v56
    v_mul_f32 v57, v22, v57
    v_mul_f32 v58, v22, v58
    v_mul_f32 v59, v22, v59
    v_mul_f32 v60, v22, v60
    v_mul_f32 v61, v22, v61
    s_waitcnt lgkmcnt(6)
    v_mfma_f32_32x32x16_bf16 v[160:175], v[96:99], v[128:131], 0
    v_mul_f32 v62, v22, v62
    v_mul_f32 v63, v22, v63
    v_mul_f32 v64, v22, v64
    v_mul_f32 v65, v22, v65
    v_mul_f32 v66, v22, v66
    v_mul_f32 v67, v22, v67
    v_mfma_f32_32x32x16_bf16 v[176:191], v[100:103], v[128:131], 0
    ds_read_b128 v[96:99], v5 offset:49152
    ds_read_b128 v[100:103], v5 offset:57344
    v_mul_f32 v68, v22, v68
    v_mul_f32 v69, v22, v69
    v_mul_f32 v70, v22, v70
    v_mul_f32 v71, v22, v71
    v_mul_f32 v72, v22, v72
    v_mul_f32 v73, v22, v73
    s_waitcnt lgkmcnt(6)
    v_mfma_f32_32x32x16_bf16 v[160:175], v[104:107], v[132:135], v[160:175]
    v_mul_f32 v74, v22, v74
    v_mul_f32 v75, v22, v75
    v_mul_f32 v76, v22, v76
    v_mul_f32 v77, v22, v77
    v_mul_f32 v78, v22, v78
    v_mul_f32 v79, v22, v79
    v_mfma_f32_32x32x16_bf16 v[176:191], v[108:111], v[132:135], v[176:191]
    ds_read_b128 v[104:107], v6 offset:49152
    ds_read_b128 v[108:111], v6 offset:57344
    v_mul_f32 v80, v22, v80
    v_mul_f32 v81, v22, v81
    v_mul_f32 v82, v22, v82
    v_mul_f32 v83, v22, v83
    v_mul_f32 v84, v22, v84
    v_mul_f32 v85, v22, v85
    s_waitcnt lgkmcnt(6)
    v_mfma_f32_32x32x16_bf16 v[160:175], v[112:115], v[136:139], v[160:175]
    v_mul_f32 v86, v22, v86
    v_mul_f32 v87, v22, v87
    v_mul_f32 v88, v22, v88
    v_mul_f32 v89, v22, v89
    v_mul_f32 v90, v22, v90
    v_mul_f32 v91, v22, v91
    v_mfma_f32_32x32x16_bf16 v[176:191], v[116:119], v[136:139], v[176:191]
    ds_read_b128 v[112:115], v7 offset:49152
    ds_read_b128 v[116:119], v7 offset:57344
    v_mul_f32 v92, v22, v92
    v_mul_f32 v93, v22, v93
    v_mul_f32 v94, v22, v94
    v_mul_f32 v95, v22, v95
    v_exp_f32 v210, v210
    s_waitcnt lgkmcnt(6)
    v_mfma_f32_32x32x16_bf16 v[160:175], v[120:123], v[140:143], v[160:175]
    v_exp_f32 v211, v211
    v_exp_f32 v212, v212
    v_exp_f32 v213, v213
    v_mfma_f32_32x32x16_bf16 v[176:191], v[124:127], v[140:143], v[176:191]
    ds_read_b128 v[120:123], v8 offset:49152
    ds_read_b128 v[124:127], v8 offset:57344
    v_exp_f32 v214, v214
    v_exp_f32 v215, v215
    v_add_f32 v21, v21, v208
    v_add_f32 v26, v26, v209
    s_waitcnt lgkmcnt(6)
    v_mfma_f32_32x32x16_bf16 v[160:175], v[96:99], v[144:147], v[160:175]
    v_add_f32 v21, v21, v210
    v_add_f32 v26, v26, v211
    v_add_f32 v21, v21, v212
    v_add_f32 v26, v26, v213
    v_add_f32 v21, v21, v214
    v_add_f32 v26, v26, v215
    v_mfma_f32_32x32x16_bf16 v[176:191], v[100:103], v[144:147], v[176:191]
    v_cvt_pk_bf16_f32 v248, v208, v209
    v_cvt_pk_bf16_f32 v249, v210, v211
    v_cvt_pk_bf16_f32 v250, v212, v213
    v_cvt_pk_bf16_f32 v251, v214, v215
    v_fma_f32 v216, v216, s50, -v23
    v_fma_f32 v217, v217, s50, -v23
    s_waitcnt lgkmcnt(4)
    v_mfma_f32_32x32x16_bf16 v[160:175], v[104:107], v[148:151], v[160:175]
    v_fma_f32 v218, v218, s50, -v23
    v_fma_f32 v219, v219, s50, -v23
    v_fma_f32 v220, v220, s50, -v23
    v_fma_f32 v221, v221, s50, -v23
    v_fma_f32 v222, v222, s50, -v23
    v_fma_f32 v223, v223, s50, -v23
    v_mfma_f32_32x32x16_bf16 v[176:191], v[108:111], v[148:151], v[176:191]
    v_exp_f32 v216, v216
    v_exp_f32 v217, v217
    v_exp_f32 v218, v218
    s_waitcnt lgkmcnt(2)
    v_mfma_f32_32x32x16_bf16 v[160:175], v[112:115], v[152:155], v[160:175]
    v_exp_f32 v219, v219
    v_exp_f32 v220, v220
    v_exp_f32 v221, v221
    v_mfma_f32_32x32x16_bf16 v[176:191], v[116:119], v[152:155], v[176:191]
    v_exp_f32 v222, v222
    v_exp_f32 v223, v223
    v_add_f32 v21, v21, v216
    v_add_f32 v26, v26, v217
    s_waitcnt lgkmcnt(0)
    v_mfma_f32_32x32x16_bf16 v[160:175], v[120:123], v[156:159], v[160:175]
    v_add_f32 v21, v21, v218
    v_add_f32 v26, v26, v219
    v_add_f32 v21, v21, v220
    v_add_f32 v26, v26, v221
    v_add_f32 v21, v21, v222
    v_add_f32 v26, v26, v223
    v_mfma_f32_32x32x16_bf16 v[176:191], v[124:127], v[156:159], v[176:191]
    v_cvt_pk_bf16_f32 v252, v216, v217
    v_cvt_pk_bf16_f32 v253, v218, v219
    v_cvt_pk_bf16_f32 v254, v220, v221
    v_cvt_pk_bf16_f32 v255, v222, v223
    v_add_f32 v21, v21, v26
    s_waitcnt lgkmcnt(0)
    s_barrier
    v_add_u32 v1, 65536, v1
    v_add_u32 v2, 65536, v2
    v_add_u32 v3, 65536, v3
    v_add_u32 v4, 65536, v4
    v_add_u32 v5, 65536, v5
    v_add_u32 v6, 65536, v6
    v_add_u32 v7, 65536, v7
    v_add_u32 v8, 65536, v8
    v_add_u32 v9, 65536, v9
    v_add_u32 v10, 65536, v10
    v_add_u32 v11, 65536, v11
    v_add_u32 v12, 65536, v12
    ds_read_b64_tr_b16 v[96:97], v9 offset:0
    ds_read_b64_tr_b16 v[98:99], v9 offset:2048
    ds_read_b64_tr_b16 v[100:101], v10 offset:0
    ds_read_b64_tr_b16 v[102:103], v10 offset:2048
    ds_read_b64_tr_b16 v[104:105], v11 offset:0
    ds_read_b64_tr_b16 v[106:107], v11 offset:2048
    ds_read_b64_tr_b16 v[108:109], v12 offset:0
    ds_read_b64_tr_b16 v[110:111], v12 offset:2048
    ds_read_b64_tr_b16 v[112:113], v9 offset:4096
    ds_read_b64_tr_b16 v[114:115], v9 offset:6144
    ds_read_b64_tr_b16 v[116:117], v10 offset:4096
    ds_read_b64_tr_b16 v[118:119], v10 offset:6144
    v_max3_f32 v24, v160, v161, v162
    v_max3_f32 v25, v163, v164, v165
    v_max3_f32 v24, v24, v166, v167
    v_max3_f32 v25, v25, v168, v169
    v_max3_f32 v24, v24, v170, v171
    v_max3_f32 v25, v25, v172, v173
    v_max3_f32 v24, v24, v174, v175
    v_max3_f32 v25, v25, v176, v177
    v_max3_f32 v24, v24, v178, v179
    v_max3_f32 v25, v25, v180, v181
    v_max3_f32 v24, v24, v182, v183
    v_max3_f32 v25, v25, v184, v185
    v_max3_f32 v24, v24, v186, v187
    v_max3_f32 v25, v25, v188, v189
    v_max3_f32 v24, v24, v190, v191
    v_max_f32 v24, v24, v25
    v_mov_b32 v25, v24
    s_nop 1
    v_permlane32_swap_b32 v24, v25
    v_max3_f32 v24, v24, v25, v20
    v_sub_f32 v25, v20, v24
    v_mul_f32 v25, s50, v25
    v_exp_f32 v22, v25
    v_mov_b32 v20, v24
    v_mul_f32 v23, s50, v20
    v_fma_f32 v160, v160, s50, -v23
    v_fma_f32 v161, v161, s50, -v23
    v_fma_f32 v162, v162, s50, -v23
    v_fma_f32 v163, v163, s50, -v23
    v_fma_f32 v164, v164, s50, -v23
    s_waitcnt lgkmcnt(8)
    v_mfma_f32_32x32x16_bf16 v[32:47], v[96:99], v[240:243], v[32:47]
    v_fma_f32 v165, v165, s50, -v23
    v_fma_f32 v166, v166, s50, -v23
    v_fma_f32 v167, v167, s50, -v23
    v_exp_f32 v160, v160
    v_mfma_f32_32x32x16_bf16 v[48:63], v[100:103], v[240:243], v[48:63]
    ds_read_b64_tr_b16 v[120:121], v11 offset:4096
    ds_read_b64_tr_b16 v[122:123], v11 offset:6144
    ds_read_b64_tr_b16 v[124:125], v12 offset:4096
    ds_read_b64_tr_b16 v[126:127], v12 offset:6144
    v_exp_f32 v161, v161
    v_exp_f32 v162, v162
    v_exp_f32 v163, v163
    s_waitcnt lgkmcnt(8)
    v_mfma_f32_32x32x16_bf16 v[64:79], v[104:107], v[240:243], v[64:79]
    v_exp_f32 v164, v164
    v_exp_f32 v165, v165
    v_mfma_f32_32x32x16_bf16 v[80:95], v[108:111], v[240:243], v[80:95]
    ds_read_b64_tr_b16 v[96:97], v9 offset:8192
    ds_read_b64_tr_b16 v[98:99], v9 offset:10240
    ds_read_b64_tr_b16 v[100:101], v10 offset:8192
    ds_read_b64_tr_b16 v[102:103], v10 offset:10240
    v_exp_f32 v166, v166
    v_exp_f32 v167, v167
    v_fma_f32 v21, v21, v22, v160
    s_waitcnt lgkmcnt(8)
    v_mfma_f32_32x32x16_bf16 v[32:47], v[112:115], v[244:247], v[32:47]
    v_mov_b32 v26, v161
    v_add_f32 v21, v21, v162
    v_add_f32 v26, v26, v163
    v_add_f32 v21, v21, v164
    v_add_f32 v26, v26, v165
    v_mfma_f32_32x32x16_bf16 v[48:63], v[116:119], v[244:247], v[48:63]
    ds_read_b64_tr_b16 v[104:105], v11 offset:8192
    ds_read_b64_tr_b16 v[106:107], v11 offset:10240
    ds_read_b64_tr_b16 v[108:109], v12 offset:8192
    ds_read_b64_tr_b16 v[110:111], v12 offset:10240
    v_add_f32 v21, v21, v166
    v_add_f32 v26, v26, v167
    v_cvt_pk_bf16_f32 v224, v160, v161
    v_cvt_pk_bf16_f32 v225, v162, v163
    v_cvt_pk_bf16_f32 v226, v164, v165
    s_waitcnt lgkmcnt(8)
    v_mfma_f32_32x32x16_bf16 v[64:79], v[120:123], v[244:247], v[64:79]
    v_cvt_pk_bf16_f32 v227, v166, v167
    v_fma_f32 v168, v168, s50, -v23
    v_fma_f32 v169, v169, s50, -v23
    v_fma_f32 v170, v170, s50, -v23
    v_fma_f32 v171, v171, s50, -v23
    v_mfma_f32_32x32x16_bf16 v[80:95], v[124:127], v[244:247], v[80:95]
    ds_read_b64_tr_b16 v[112:113], v9 offset:12288
    ds_read_b64_tr_b16 v[114:115], v9 offset:14336
    ds_read_b64_tr_b16 v[116:117], v10 offset:12288
    ds_read_b64_tr_b16 v[118:119], v10 offset:14336
    v_fma_f32 v172, v172, s50, -v23
    v_fma_f32 v173, v173, s50, -v23
    v_fma_f32 v174, v174, s50, -v23
    v_fma_f32 v175, v175, s50, -v23
    v_exp_f32 v168, v168
    s_waitcnt lgkmcnt(8)
    v_mfma_f32_32x32x16_bf16 v[32:47], v[96:99], v[248:251], v[32:47]
    v_exp_f32 v169, v169
    v_exp_f32 v170, v170
    v_mfma_f32_32x32x16_bf16 v[48:63], v[100:103], v[248:251], v[48:63]
    ds_read_b64_tr_b16 v[120:121], v11 offset:12288
    ds_read_b64_tr_b16 v[122:123], v11 offset:14336
    ds_read_b64_tr_b16 v[124:125], v12 offset:12288
    ds_read_b64_tr_b16 v[126:127], v12 offset:14336
    v_exp_f32 v171, v171
    v_exp_f32 v172, v172
    v_exp_f32 v173, v173
    s_waitcnt lgkmcnt(8)
    v_mfma_f32_32x32x16_bf16 v[64:79], v[104:107], v[248:251], v[64:79]
    v_exp_f32 v174, v174
    v_exp_f32 v175, v175
    v_mfma_f32_32x32x16_bf16 v[80:95], v[108:111], v[248:251], v[80:95]
    v_add_f32 v21, v21, v168
    v_add_f32 v26, v26, v169
    v_add_f32 v21, v21, v170
    v_add_f32 v26, v26, v171
    v_add_f32 v21, v21, v172
    s_waitcnt lgkmcnt(4)
    v_mfma_f32_32x32x16_bf16 v[32:47], v[112:115], v[252:255], v[32:47]
    v_add_f32 v26, v26, v173
    v_add_f32 v21, v21, v174
    v_add_f32 v26, v26, v175
    v_cvt_pk_bf16_f32 v228, v168, v169
    v_cvt_pk_bf16_f32 v229, v170, v171
    v_mfma_f32_32x32x16_bf16 v[48:63], v[116:119], v[252:255], v[48:63]
    v_cvt_pk_bf16_f32 v230, v172, v173
    v_cvt_pk_bf16_f32 v231, v174, v175
    v_fma_f32 v176, v176, s50, -v23
    v_fma_f32 v177, v177, s50, -v23
    v_fma_f32 v178, v178, s50, -v23
    s_waitcnt lgkmcnt(0)
    v_mfma_f32_32x32x16_bf16 v[64:79], v[120:123], v[252:255], v[64:79]
    v_fma_f32 v179, v179, s50, -v23
    v_fma_f32 v180, v180, s50, -v23
    v_fma_f32 v181, v181, s50, -v23
    v_fma_f32 v182, v182, s50, -v23
    v_fma_f32 v183, v183, s50, -v23
    v_mfma_f32_32x32x16_bf16 v[80:95], v[124:127], v[252:255], v[80:95]
    v_exp_f32 v176, v176
    v_exp_f32 v177, v177
    s_waitcnt lgkmcnt(0)
    s_barrier
    ds_read_b128 v[96:99], v1 offset:16384
    ds_read_b128 v[100:103], v1 offset:24576
    ds_read_b128 v[104:107], v2 offset:16384
    ds_read_b128 v[108:111], v2 offset:24576
    ds_read_b128 v[112:115], v3 offset:16384
    ds_read_b128 v[116:119], v3 offset:24576
    ds_read_b128 v[120:123], v4 offset:16384
    ds_read_b128 v[124:127], v4 offset:24576
    v_mul_f32 v32, v22, v32
    v_mul_f32 v33, v22, v33
    v_mul_f32 v34, v22, v34
    v_mul_f32 v35, v22, v35
    v_mul_f32 v36, v22, v36
    v_mul_f32 v37, v22, v37
    v_mul_f32 v38, v22, v38
    v_mul_f32 v39, v22, v39
    v_mul_f32 v40, v22, v40
    v_mul_f32 v41, v22, v41
    v_mul_f32 v42, v22, v42
    v_mul_f32 v43, v22, v43
    v_mul_f32 v44, v22, v44
    v_mul_f32 v45, v22, v45
    v_mul_f32 v46, v22, v46
    v_mul_f32 v47, v22, v47
    v_mul_f32 v48, v22, v48
    v_mul_f32 v49, v22, v49
    v_mul_f32 v50, v22, v50
    v_mul_f32 v51, v22, v51
    v_mul_f32 v52, v22, v52
    v_mul_f32 v53, v22, v53
    v_mul_f32 v54, v22, v54
    v_mul_f32 v55, v22, v55
    v_mul_f32 v56, v22, v56
    v_mul_f32 v57, v22, v57
    v_mul_f32 v58, v22, v58
    v_mul_f32 v59, v22, v59
    v_mul_f32 v60, v22, v60
    v_mul_f32 v61, v22, v61
    s_waitcnt lgkmcnt(6)
    v_mfma_f32_32x32x16_bf16 v[192:207], v[96:99], v[128:131], 0
    v_mul_f32 v62, v22, v62
    v_mul_f32 v63, v22, v63
    v_mul_f32 v64, v22, v64
    v_mul_f32 v65, v22, v65
    v_mul_f32 v66, v22, v66
    v_mul_f32 v67, v22, v67
    v_mfma_f32_32x32x16_bf16 v[208:223], v[100:103], v[128:131], 0
    ds_read_b128 v[96:99], v5 offset:16384
    ds_read_b128 v[100:103], v5 offset:24576
    v_mul_f32 v68, v22, v68
    v_mul_f32 v69, v22, v69
    v_mul_f32 v70, v22, v70
    v_mul_f32 v71, v22, v71
    v_mul_f32 v72, v22, v72
    v_mul_f32 v73, v22, v73
    s_waitcnt lgkmcnt(6)
    v_mfma_f32_32x32x16_bf16 v[192:207], v[104:107], v[132:135], v[192:207]
    v_mul_f32 v74, v22, v74
    v_mul_f32 v75, v22, v75
    v_mul_f32 v76, v22, v76
    v_mul_f32 v77, v22, v77
    v_mul_f32 v78, v22, v78
    v_mul_f32 v79, v22, v79
    v_mfma_f32_32x32x16_bf16 v[208:223], v[108:111], v[132:135], v[208:223]
    ds_read_b128 v[104:107], v6 offset:16384
    ds_read_b128 v[108:111], v6 offset:24576
    v_mul_f32 v80, v22, v80
    v_mul_f32 v81, v22, v81
    v_mul_f32 v82, v22, v82
    v_mul_f32 v83, v22, v83
    v_mul_f32 v84, v22, v84
    v_mul_f32 v85, v22, v85
    s_waitcnt lgkmcnt(6)
    v_mfma_f32_32x32x16_bf16 v[192:207], v[112:115], v[136:139], v[192:207]
    v_mul_f32 v86, v22, v86
    v_mul_f32 v87, v22, v87
    v_mul_f32 v88, v22, v88
    v_mul_f32 v89, v22, v89
    v_mul_f32 v90, v22, v90
    v_mul_f32 v91, v22, v91
    v_mfma_f32_32x32x16_bf16 v[208:223], v[116:119], v[136:139], v[208:223]
    ds_read_b128 v[112:115], v7 offset:16384
    ds_read_b128 v[116:119], v7 offset:24576
    v_mul_f32 v92, v22, v92
    v_mul_f32 v93, v22, v93
    v_mul_f32 v94, v22, v94
    v_mul_f32 v95, v22, v95
    v_exp_f32 v178, v178
    s_waitcnt lgkmcnt(6)
    v_mfma_f32_32x32x16_bf16 v[192:207], v[120:123], v[140:143], v[192:207]
    v_exp_f32 v179, v179
    v_exp_f32 v180, v180
    v_exp_f32 v181, v181
    v_mfma_f32_32x32x16_bf16 v[208:223], v[124:127], v[140:143], v[208:223]
    ds_read_b128 v[120:123], v8 offset:16384
    ds_read_b128 v[124:127], v8 offset:24576
    v_exp_f32 v182, v182
    v_exp_f32 v183, v183
    v_add_f32 v21, v21, v176
    v_add_f32 v26, v26, v177
    s_waitcnt lgkmcnt(6)
    v_mfma_f32_32x32x16_bf16 v[192:207], v[96:99], v[144:147], v[192:207]
    v_add_f32 v21, v21, v178
    v_add_f32 v26, v26, v179
    v_add_f32 v21, v21, v180
    v_add_f32 v26, v26, v181
    v_add_f32 v21, v21, v182
    v_add_f32 v26, v26, v183
    v_mfma_f32_32x32x16_bf16 v[208:223], v[100:103], v[144:147], v[208:223]
    v_cvt_pk_bf16_f32 v232, v176, v177
    v_cvt_pk_bf16_f32 v233, v178, v179
    v_cvt_pk_bf16_f32 v234, v180, v181
    v_cvt_pk_bf16_f32 v235, v182, v183
    v_fma_f32 v184, v184, s50, -v23
    v_fma_f32 v185, v185, s50, -v23
    s_waitcnt lgkmcnt(4)
    v_mfma_f32_32x32x16_bf16 v[192:207], v[104:107], v[148:151], v[192:207]
    v_fma_f32 v186, v186, s50, -v23
    v_fma_f32 v187, v187, s50, -v23
    v_fma_f32 v188, v188, s50, -v23
    v_fma_f32 v189, v189, s50, -v23
    v_fma_f32 v190, v190, s50, -v23
    v_fma_f32 v191, v191, s50, -v23
    v_mfma_f32_32x32x16_bf16 v[208:223], v[108:111], v[148:151], v[208:223]
    v_exp_f32 v184, v184
    v_exp_f32 v185, v185
    v_exp_f32 v186, v186
    s_waitcnt lgkmcnt(2)
    v_mfma_f32_32x32x16_bf16 v[192:207], v[112:115], v[152:155], v[192:207]
    v_exp_f32 v187, v187
    v_exp_f32 v188, v188
    v_exp_f32 v189, v189
    v_mfma_f32_32x32x16_bf16 v[208:223], v[116:119], v[152:155], v[208:223]
    v_exp_f32 v190, v190
    v_exp_f32 v191, v191
    v_add_f32 v21, v21, v184
    v_add_f32 v26, v26, v185
    s_waitcnt lgkmcnt(0)
    v_mfma_f32_32x32x16_bf16 v[192:207], v[120:123], v[156:159], v[192:207]
    v_add_f32 v21, v21, v186
    v_add_f32 v26, v26, v187
    v_add_f32 v21, v21, v188
    v_add_f32 v26, v26, v189
    v_add_f32 v21, v21, v190
    v_add_f32 v26, v26, v191
    v_mfma_f32_32x32x16_bf16 v[208:223], v[124:127], v[156:159], v[208:223]
    v_cvt_pk_bf16_f32 v236, v184, v185
    v_cvt_pk_bf16_f32 v237, v186, v187
    v_cvt_pk_bf16_f32 v238, v188, v189
    v_cvt_pk_bf16_f32 v239, v190, v191
    v_add_f32 v21, v21, v26
    s_waitcnt lgkmcnt(0)
    s_barrier
    ds_read_b64_tr_b16 v[96:97], v9 offset:32768
    ds_read_b64_tr_b16 v[98:99], v9 offset:34816
    ds_read_b64_tr_b16 v[100:101], v10 offset:32768
    ds_read_b64_tr_b16 v[102:103], v10 offset:34816
    ds_read_b64_tr_b16 v[104:105], v11 offset:32768
    ds_read_b64_tr_b16 v[106:107], v11 offset:34816
    ds_read_b64_tr_b16 v[108:109], v12 offset:32768
    ds_read_b64_tr_b16 v[110:111], v12 offset:34816
    ds_read_b64_tr_b16 v[112:113], v9 offset:36864
    ds_read_b64_tr_b16 v[114:115], v9 offset:38912
    ds_read_b64_tr_b16 v[116:117], v10 offset:36864
    ds_read_b64_tr_b16 v[118:119], v10 offset:38912
    v_max3_f32 v24, v192, v193, v194
    v_max3_f32 v25, v195, v196, v197
    v_max3_f32 v24, v24, v198, v199
    v_max3_f32 v25, v25, v200, v201
    v_max3_f32 v24, v24, v202, v203
    v_max3_f32 v25, v25, v204, v205
    v_max3_f32 v24, v24, v206, v207
    v_max3_f32 v25, v25, v208, v209
    v_max3_f32 v24, v24, v210, v211
    v_max3_f32 v25, v25, v212, v213
    v_max3_f32 v24, v24, v214, v215
    v_max3_f32 v25, v25, v216, v217
    v_max3_f32 v24, v24, v218, v219
    v_max3_f32 v25, v25, v220, v221
    v_max3_f32 v24, v24, v222, v223
    v_max_f32 v24, v24, v25
    v_mov_b32 v25, v24
    s_nop 1
    v_permlane32_swap_b32 v24, v25
    v_max3_f32 v24, v24, v25, v20
    v_sub_f32 v25, v20, v24
    v_mul_f32 v25, s50, v25
    v_exp_f32 v22, v25
    v_mov_b32 v20, v24
    v_mul_f32 v23, s50, v20
    v_fma_f32 v192, v192, s50, -v23
    v_fma_f32 v193, v193, s50, -v23
    v_fma_f32 v194, v194, s50, -v23
    v_fma_f32 v195, v195, s50, -v23
    v_fma_f32 v196, v196, s50, -v23
    s_waitcnt lgkmcnt(8)
    v_mfma_f32_32x32x16_bf16 v[32:47], v[96:99], v[224:227], v[32:47]
    v_fma_f32 v197, v197, s50, -v23
    v_fma_f32 v198, v198, s50, -v23
    v_fma_f32 v199, v199, s50, -v23
    v_exp_f32 v192, v192
    v_mfma_f32_32x32x16_bf16 v[48:63], v[100:103], v[224:227], v[48:63]
    ds_read_b64_tr_b16 v[120:121], v11 offset:36864
    ds_read_b64_tr_b16 v[122:123], v11 offset:38912
    ds_read_b64_tr_b16 v[124:125], v12 offset:36864
    ds_read_b64_tr_b16 v[126:127], v12 offset:38912
    v_exp_f32 v193, v193
    v_exp_f32 v194, v194
    v_exp_f32 v195, v195
    s_waitcnt lgkmcnt(8)
    v_mfma_f32_32x32x16_bf16 v[64:79], v[104:107], v[224:227], v[64:79]
    v_exp_f32 v196, v196
    v_exp_f32 v197, v197
    v_mfma_f32_32x32x16_bf16 v[80:95], v[108:111], v[224:227], v[80:95]
    ds_read_b64_tr_b16 v[96:97], v9 offset:40960
    ds_read_b64_tr_b16 v[98:99], v9 offset:43008
    ds_read_b64_tr_b16 v[100:101], v10 offset:40960
    ds_read_b64_tr_b16 v[102:103], v10 offset:43008
    v_exp_f32 v198, v198
    v_exp_f32 v199, v199
    v_fma_f32 v21, v21, v22, v192
    s_waitcnt lgkmcnt(8)
    v_mfma_f32_32x32x16_bf16 v[32:47], v[112:115], v[228:231], v[32:47]
    v_mov_b32 v26, v193
    v_add_f32 v21, v21, v194
    v_add_f32 v26, v26, v195
    v_add_f32 v21, v21, v196
    v_add_f32 v26, v26, v197
    v_mfma_f32_32x32x16_bf16 v[48:63], v[116:119], v[228:231], v[48:63]
    ds_read_b64_tr_b16 v[104:105], v11 offset:40960
    ds_read_b64_tr_b16 v[106:107], v11 offset:43008
    ds_read_b64_tr_b16 v[108:109], v12 offset:40960
    ds_read_b64_tr_b16 v[110:111], v12 offset:43008
    v_add_f32 v21, v21, v198
    v_add_f32 v26, v26, v199
    v_cvt_pk_bf16_f32 v240, v192, v193
    v_cvt_pk_bf16_f32 v241, v194, v195
    v_cvt_pk_bf16_f32 v242, v196, v197
    s_waitcnt lgkmcnt(8)
    v_mfma_f32_32x32x16_bf16 v[64:79], v[120:123], v[228:231], v[64:79]
    v_cvt_pk_bf16_f32 v243, v198, v199
    v_fma_f32 v200, v200, s50, -v23
    v_fma_f32 v201, v201, s50, -v23
    v_fma_f32 v202, v202, s50, -v23
    v_fma_f32 v203, v203, s50, -v23
    v_mfma_f32_32x32x16_bf16 v[80:95], v[124:127], v[228:231], v[80:95]
    ds_read_b64_tr_b16 v[112:113], v9 offset:45056
    ds_read_b64_tr_b16 v[114:115], v9 offset:47104
    ds_read_b64_tr_b16 v[116:117], v10 offset:45056
    ds_read_b64_tr_b16 v[118:119], v10 offset:47104
    v_fma_f32 v204, v204, s50, -v23
    v_fma_f32 v205, v205, s50, -v23
    v_fma_f32 v206, v206, s50, -v23
    v_fma_f32 v207, v207, s50, -v23
    v_exp_f32 v200, v200
    s_waitcnt lgkmcnt(8)
    v_mfma_f32_32x32x16_bf16 v[32:47], v[96:99], v[232:235], v[32:47]
    v_exp_f32 v201, v201
    v_exp_f32 v202, v202
    v_mfma_f32_32x32x16_bf16 v[48:63], v[100:103], v[232:235], v[48:63]
    ds_read_b64_tr_b16 v[120:121], v11 offset:45056
    ds_read_b64_tr_b16 v[122:123], v11 offset:47104
    ds_read_b64_tr_b16 v[124:125], v12 offset:45056
    ds_read_b64_tr_b16 v[126:127], v12 offset:47104
    v_exp_f32 v203, v203
    v_exp_f32 v204, v204
    v_exp_f32 v205, v205
    s_waitcnt lgkmcnt(8)
    v_mfma_f32_32x32x16_bf16 v[64:79], v[104:107], v[232:235], v[64:79]
    v_exp_f32 v206, v206
    v_exp_f32 v207, v207
    v_mfma_f32_32x32x16_bf16 v[80:95], v[108:111], v[232:235], v[80:95]
    v_add_f32 v21, v21, v200
    v_add_f32 v26, v26, v201
    v_add_f32 v21, v21, v202
    v_add_f32 v26, v26, v203
    v_add_f32 v21, v21, v204
    s_waitcnt lgkmcnt(4)
    v_mfma_f32_32x32x16_bf16 v[32:47], v[112:115], v[236:239], v[32:47]
    v_add_f32 v26, v26, v205
    v_add_f32 v21, v21, v206
    v_add_f32 v26, v26, v207
    v_cvt_pk_bf16_f32 v244, v200, v201
    v_cvt_pk_bf16_f32 v245, v202, v203
    v_mfma_f32_32x32x16_bf16 v[48:63], v[116:119], v[236:239], v[48:63]
    v_cvt_pk_bf16_f32 v246, v204, v205
    v_cvt_pk_bf16_f32 v247, v206, v207
    v_fma_f32 v208, v208, s50, -v23
    v_fma_f32 v209, v209, s50, -v23
    v_fma_f32 v210, v210, s50, -v23
    s_waitcnt lgkmcnt(0)
    v_mfma_f32_32x32x16_bf16 v[64:79], v[120:123], v[236:239], v[64:79]
    v_fma_f32 v211, v211, s50, -v23
    v_fma_f32 v212, v212, s50, -v23
    v_fma_f32 v213, v213, s50, -v23
    v_fma_f32 v214, v214, s50, -v23
    v_fma_f32 v215, v215, s50, -v23
    v_mfma_f32_32x32x16_bf16 v[80:95], v[124:127], v[236:239], v[80:95]
    v_exp_f32 v208, v208
    v_exp_f32 v209, v209
    s_waitcnt lgkmcnt(0)
    s_barrier
    ds_read_b128 v[96:99], v1 offset:49152
    ds_read_b128 v[100:103], v1 offset:57344
    ds_read_b128 v[104:107], v2 offset:49152
    ds_read_b128 v[108:111], v2 offset:57344
    ds_read_b128 v[112:115], v3 offset:49152
    ds_read_b128 v[116:119], v3 offset:57344
    ds_read_b128 v[120:123], v4 offset:49152
    ds_read_b128 v[124:127], v4 offset:57344
    v_mul_f32 v32, v22, v32
    v_mul_f32 v33, v22, v33
    v_mul_f32 v34, v22, v34
    v_mul_f32 v35, v22, v35
    v_mul_f32 v36, v22, v36
    v_mul_f32 v37, v22, v37
    v_mul_f32 v38, v22, v38
    v_mul_f32 v39, v22, v39
    v_mul_f32 v40, v22, v40
    v_mul_f32 v41, v22, v41
    v_mul_f32 v42, v22, v42
    v_mul_f32 v43, v22, v43
    v_mul_f32 v44, v22, v44
    v_mul_f32 v45, v22, v45
    v_mul_f32 v46, v22, v46
    v_mul_f32 v47, v22, v47
    v_mul_f32 v48, v22, v48
    v_mul_f32 v49, v22, v49
    v_mul_f32 v50, v22, v50
    v_mul_f32 v51, v22, v51
    v_mul_f32 v52, v22, v52
    v_mul_f32 v53, v22, v53
    v_mul_f32 v54, v22, v54
    v_mul_f32 v55, v22, v55
    v_mul_f32 v56, v22, v56
    v_mul_f32 v57, v22, v57
    v_mul_f32 v58, v22, v58
    v_mul_f32 v59, v22, v59
    v_mul_f32 v60, v22, v60
    v_mul_f32 v61, v22, v61
    s_waitcnt lgkmcnt(6)
    v_mfma_f32_32x32x16_bf16 v[160:175], v[96:99], v[128:131], 0
    v_mul_f32 v62, v22, v62
    v_mul_f32 v63, v22, v63
    v_mul_f32 v64, v22, v64
    v_mul_f32 v65, v22, v65
    v_mul_f32 v66, v22, v66
    v_mul_f32 v67, v22, v67
    v_mfma_f32_32x32x16_bf16 v[176:191], v[100:103], v[128:131], 0
    ds_read_b128 v[96:99], v5 offset:49152
    ds_read_b128 v[100:103], v5 offset:57344
    v_mul_f32 v68, v22, v68
    v_mul_f32 v69, v22, v69
    v_mul_f32 v70, v22, v70
    v_mul_f32 v71, v22, v71
    v_mul_f32 v72, v22, v72
    v_mul_f32 v73, v22, v73
    s_waitcnt lgkmcnt(6)
    v_mfma_f32_32x32x16_bf16 v[160:175], v[104:107], v[132:135], v[160:175]
    v_mul_f32 v74, v22, v74
    v_mul_f32 v75, v22, v75
    v_mul_f32 v76, v22, v76
    v_mul_f32 v77, v22, v77
    v_mul_f32 v78, v22, v78
    v_mul_f32 v79, v22, v79
    v_mfma_f32_32x32x16_bf16 v[176:191], v[108:111], v[132:135], v[176:191]
    ds_read_b128 v[104:107], v6 offset:49152
    ds_read_b128 v[108:111], v6 offset:57344
    v_mul_f32 v80, v22, v80
    v_mul_f32 v81, v22, v81
    v_mul_f32 v82, v22, v82
    v_mul_f32 v83, v22, v83
    v_mul_f32 v84, v22, v84
    v_mul_f32 v85, v22, v85
    s_waitcnt lgkmcnt(6)
    v_mfma_f32_32x32x16_bf16 v[160:175], v[112:115], v[136:139], v[160:175]
    v_mul_f32 v86, v22, v86
    v_mul_f32 v87, v22, v87
    v_mul_f32 v88, v22, v88
    v_mul_f32 v89, v22, v89
    v_mul_f32 v90, v22, v90
    v_mul_f32 v91, v22, v91
    v_mfma_f32_32x32x16_bf16 v[176:191], v[116:119], v[136:139], v[176:191]
    ds_read_b128 v[112:115], v7 offset:49152
    ds_read_b128 v[116:119], v7 offset:57344
    v_mul_f32 v92, v22, v92
    v_mul_f32 v93, v22, v93
    v_mul_f32 v94, v22, v94
    v_mul_f32 v95, v22, v95
    v_exp_f32 v210, v210
    s_waitcnt lgkmcnt(6)
    v_mfma_f32_32x32x16_bf16 v[160:175], v[120:123], v[140:143], v[160:175]
    v_exp_f32 v211, v211
    v_exp_f32 v212, v212
    v_exp_f32 v213, v213
    v_mfma_f32_32x32x16_bf16 v[176:191], v[124:127], v[140:143], v[176:191]
    ds_read_b128 v[120:123], v8 offset:49152
    ds_read_b128 v[124:127], v8 offset:57344
    v_exp_f32 v214, v214
    v_exp_f32 v215, v215
    v_add_f32 v21, v21, v208
    v_add_f32 v26, v26, v209
    s_waitcnt lgkmcnt(6)
    v_mfma_f32_32x32x16_bf16 v[160:175], v[96:99], v[144:147], v[160:175]
    v_add_f32 v21, v21, v210
    v_add_f32 v26, v26, v211
    v_add_f32 v21, v21, v212
    v_add_f32 v26, v26, v213
    v_add_f32 v21, v21, v214
    v_add_f32 v26, v26, v215
    v_mfma_f32_32x32x16_bf16 v[176:191], v[100:103], v[144:147], v[176:191]
    v_cvt_pk_bf16_f32 v248, v208, v209
    v_cvt_pk_bf16_f32 v249, v210, v211
    v_cvt_pk_bf16_f32 v250, v212, v213
    v_cvt_pk_bf16_f32 v251, v214, v215
    v_fma_f32 v216, v216, s50, -v23
    v_fma_f32 v217, v217, s50, -v23
    s_waitcnt lgkmcnt(4)
    v_mfma_f32_32x32x16_bf16 v[160:175], v[104:107], v[148:151], v[160:175]
    v_fma_f32 v218, v218, s50, -v23
    v_fma_f32 v219, v219, s50, -v23
    v_fma_f32 v220, v220, s50, -v23
    v_fma_f32 v221, v221, s50, -v23
    v_fma_f32 v222, v222, s50, -v23
    v_fma_f32 v223, v223, s50, -v23
    v_mfma_f32_32x32x16_bf16 v[176:191], v[108:111], v[148:151], v[176:191]
    v_exp_f32 v216, v216
    v_exp_f32 v217, v217
    v_exp_f32 v218, v218
    s_waitcnt lgkmcnt(2)
    v_mfma_f32_32x32x16_bf16 v[160:175], v[112:115], v[152:155], v[160:175]
    v_exp_f32 v219, v219
    v_exp_f32 v220, v220
    v_exp_f32 v221, v221
    v_mfma_f32_32x32x16_bf16 v[176:191], v[116:119], v[152:155], v[176:191]
    v_exp_f32 v222, v222
    v_exp_f32 v223, v223
    v_add_f32 v21, v21, v216
    v_add_f32 v26, v26, v217
    s_waitcnt lgkmcnt(0)
    v_mfma_f32_32x32x16_bf16 v[160:175], v[120:123], v[156:159], v[160:175]
    v_add_f32 v21, v21, v218
    v_add_f32 v26, v26, v219
    v_add_f32 v21, v21, v220
    v_add_f32 v26, v26, v221
    v_add_f32 v21, v21, v222
    v_add_f32 v26, v26, v223
    v_mfma_f32_32x32x16_bf16 v[176:191], v[124:127], v[156:159], v[176:191]
    v_cvt_pk_bf16_f32 v252, v216, v217
    v_cvt_pk_bf16_f32 v253, v218, v219
    v_cvt_pk_bf16_f32 v254, v220, v221
    v_cvt_pk_bf16_f32 v255, v222, v223
    v_add_f32 v21, v21, v26
    s_waitcnt lgkmcnt(0)
    s_barrier
    v_subrev_u32 v1, 65536, v1
    v_subrev_u32 v2, 65536, v2
    v_subrev_u32 v3, 65536, v3
    v_subrev_u32 v4, 65536, v4
    v_subrev_u32 v5, 65536, v5
    v_subrev_u32 v6, 65536, v6
    v_subrev_u32 v7, 65536, v7
    v_subrev_u32 v8, 65536, v8
    v_subrev_u32 v9, 65536, v9
    v_subrev_u32 v10, 65536, v10
    v_subrev_u32 v11, 65536, v11
    v_subrev_u32 v12, 65536, v12
    ds_read_b64_tr_b16 v[96:97], v9 offset:0
    ds_read_b64_tr_b16 v[98:99], v9 offset:2048
    ds_read_b64_tr_b16 v[100:101], v10 offset:0
    ds_read_b64_tr_b16 v[102:103], v10 offset:2048
    ds_read_b64_tr_b16 v[104:105], v11 offset:0
    ds_read_b64_tr_b16 v[106:107], v11 offset:2048
    ds_read_b64_tr_b16 v[108:109], v12 offset:0
    ds_read_b64_tr_b16 v[110:111], v12 offset:2048
    ds_read_b64_tr_b16 v[112:113], v9 offset:4096
    ds_read_b64_tr_b16 v[114:115], v9 offset:6144
    ds_read_b64_tr_b16 v[116:117], v10 offset:4096
    ds_read_b64_tr_b16 v[118:119], v10 offset:6144
    v_max3_f32 v24, v160, v161, v162
    v_max3_f32 v25, v163, v164, v165
    v_max3_f32 v24, v24, v166, v167
    v_max3_f32 v25, v25, v168, v169
    v_max3_f32 v24, v24, v170, v171
    v_max3_f32 v25, v25, v172, v173
    v_max3_f32 v24, v24, v174, v175
    v_max3_f32 v25, v25, v176, v177
    v_max3_f32 v24, v24, v178, v179
    v_max3_f32 v25, v25, v180, v181
    v_max3_f32 v24, v24, v182, v183
    v_max3_f32 v25, v25, v184, v185
    v_max3_f32 v24, v24, v186, v187
    v_max3_f32 v25, v25, v188, v189
    v_max3_f32 v24, v24, v190, v191
    v_max_f32 v24, v24, v25
    v_mov_b32 v25, v24
    s_nop 1
    v_permlane32_swap_b32 v24, v25
    v_max3_f32 v24, v24, v25, v20
    v_sub_f32 v25, v20, v24
    v_mul_f32 v25, s50, v25
    v_exp_f32 v22, v25
    v_mov_b32 v20, v24
    v_mul_f32 v23, s50, v20
    v_fma_f32 v160, v160, s50, -v23
    v_fma_f32 v161, v161, s50, -v23
    v_fma_f32 v162, v162, s50, -v23
    v_fma_f32 v163, v163, s50, -v23
    v_fma_f32 v164, v164, s50, -v23
    s_waitcnt lgkmcnt(8)
    v_mfma_f32_32x32x16_bf16 v[32:47], v[96:99], v[240:243], v[32:47]
    v_fma_f32 v165, v165, s50, -v23
    v_fma_f32 v166, v166, s50, -v23
    v_fma_f32 v167, v167, s50, -v23
    v_exp_f32 v160, v160
    v_mfma_f32_32x32x16_bf16 v[48:63], v[100:103], v[240:243], v[48:63]
    ds_read_b64_tr_b16 v[120:121], v11 offset:4096
    ds_read_b64_tr_b16 v[122:123], v11 offset:6144
    ds_read_b64_tr_b16 v[124:125], v12 offset:4096
    ds_read_b64_tr_b16 v[126:127], v12 offset:6144
    v_exp_f32 v161, v161
    v_exp_f32 v162, v162
    v_exp_f32 v163, v163
    s_waitcnt lgkmcnt(8)
    v_mfma_f32_32x32x16_bf16 v[64:79], v[104:107], v[240:243], v[64:79]
    v_exp_f32 v164, v164
    v_exp_f32 v165, v165
    v_mfma_f32_32x32x16_bf16 v[80:95], v[108:111], v[240:243], v[80:95]
    ds_read_b64_tr_b16 v[96:97], v9 offset:8192
    ds_read_b64_tr_b16 v[98:99], v9 offset:10240
    ds_read_b64_tr_b16 v[100:101], v10 offset:8192
    ds_read_b64_tr_b16 v[102:103], v10 offset:10240
    v_exp_f32 v166, v166
    v_exp_f32 v167, v167
    v_fma_f32 v21, v21, v22, v160
    s_waitcnt lgkmcnt(8)
    v_mfma_f32_32x32x16_bf16 v[32:47], v[112:115], v[244:247], v[32:47]
    v_mov_b32 v26, v161
    v_add_f32 v21, v21, v162
    v_add_f32 v26, v26, v163
    v_add_f32 v21, v21, v164
    v_add_f32 v26, v26, v165
    v_mfma_f32_32x32x16_bf16 v[48:63], v[116:119], v[244:247], v[48:63]
    ds_read_b64_tr_b16 v[104:105], v11 offset:8192
    ds_read_b64_tr_b16 v[106:107], v11 offset:10240
    ds_read_b64_tr_b16 v[108:109], v12 offset:8192
    ds_read_b64_tr_b16 v[110:111], v12 offset:10240
    v_add_f32 v21, v21, v166
    v_add_f32 v26, v26, v167
    v_cvt_pk_bf16_f32 v224, v160, v161
    v_cvt_pk_bf16_f32 v225, v162, v163
    v_cvt_pk_bf16_f32 v226, v164, v165
    s_waitcnt lgkmcnt(8)
    v_mfma_f32_32x32x16_bf16 v[64:79], v[120:123], v[244:247], v[64:79]
    v_cvt_pk_bf16_f32 v227, v166, v167
    v_fma_f32 v168, v168, s50, -v23
    v_fma_f32 v169, v169, s50, -v23
    v_fma_f32 v170, v170, s50, -v23
    v_fma_f32 v171, v171, s50, -v23
    v_mfma_f32_32x32x16_bf16 v[80:95], v[124:127], v[244:247], v[80:95]
    ds_read_b64_tr_b16 v[112:113], v9 offset:12288
    ds_read_b64_tr_b16 v[114:115], v9 offset:14336
    ds_read_b64_tr_b16 v[116:117], v10 offset:12288
    ds_read_b64_tr_b16 v[118:119], v10 offset:14336
    v_fma_f32 v172, v172, s50, -v23
    v_fma_f32 v173, v173, s50, -v23
    v_fma_f32 v174, v174, s50, -v23
    v_fma_f32 v175, v175, s50, -v23
    v_exp_f32 v168, v168
    s_waitcnt lgkmcnt(8)
    v_mfma_f32_32x32x16_bf16 v[32:47], v[96:99], v[248:251], v[32:47]
    v_exp_f32 v169, v169
    v_exp_f32 v170, v170
    v_mfma_f32_32x32x16_bf16 v[48:63], v[100:103], v[248:251], v[48:63]
    ds_read_b64_tr_b16 v[120:121], v11 offset:12288
    ds_read_b64_tr_b16 v[122:123], v11 offset:14336
    ds_read_b64_tr_b16 v[124:125], v12 offset:12288
    ds_read_b64_tr_b16 v[126:127], v12 offset:14336
    v_exp_f32 v171, v171
    v_exp_f32 v172, v172
    v_exp_f32 v173, v173
    s_waitcnt lgkmcnt(8)
    v_mfma_f32_32x32x16_bf16 v[64:79], v[104:107], v[248:251], v[64:79]
    v_exp_f32 v174, v174
    v_exp_f32 v175, v175
    v_mfma_f32_32x32x16_bf16 v[80:95], v[108:111], v[248:251], v[80:95]
    v_add_f32 v21, v21, v168
    v_add_f32 v26, v26, v169
    v_add_f32 v21, v21, v170
    v_add_f32 v26, v26, v171
    v_add_f32 v21, v21, v172
    s_waitcnt lgkmcnt(4)
    v_mfma_f32_32x32x16_bf16 v[32:47], v[112:115], v[252:255], v[32:47]
    v_add_f32 v26, v26, v173
    v_add_f32 v21, v21, v174
    v_add_f32 v26, v26, v175
    v_cvt_pk_bf16_f32 v228, v168, v169
    v_cvt_pk_bf16_f32 v229, v170, v171
    v_mfma_f32_32x32x16_bf16 v[48:63], v[116:119], v[252:255], v[48:63]
    v_cvt_pk_bf16_f32 v230, v172, v173
    v_cvt_pk_bf16_f32 v231, v174, v175
    v_fma_f32 v176, v176, s50, -v23
    v_fma_f32 v177, v177, s50, -v23
    v_fma_f32 v178, v178, s50, -v23
    s_waitcnt lgkmcnt(0)
    v_mfma_f32_32x32x16_bf16 v[64:79], v[120:123], v[252:255], v[64:79]
    v_fma_f32 v179, v179, s50, -v23
    v_fma_f32 v180, v180, s50, -v23
    v_fma_f32 v181, v181, s50, -v23
    v_fma_f32 v182, v182, s50, -v23
    v_fma_f32 v183, v183, s50, -v23
    v_mfma_f32_32x32x16_bf16 v[80:95], v[124:127], v[252:255], v[80:95]
    v_exp_f32 v176, v176
    v_exp_f32 v177, v177
    s_waitcnt lgkmcnt(0)
    s_barrier
    ds_read_b128 v[96:99], v1 offset:16384
    ds_read_b128 v[100:103], v1 offset:24576
    ds_read_b128 v[104:107], v2 offset:16384
    ds_read_b128 v[108:111], v2 offset:24576
    ds_read_b128 v[112:115], v3 offset:16384
    ds_read_b128 v[116:119], v3 offset:24576
    ds_read_b128 v[120:123], v4 offset:16384
    ds_read_b128 v[124:127], v4 offset:24576
    v_mul_f32 v32, v22, v32
    v_mul_f32 v33, v22, v33
    v_mul_f32 v34, v22, v34
    v_mul_f32 v35, v22, v35
    v_mul_f32 v36, v22, v36
    v_mul_f32 v37, v22, v37
    v_mul_f32 v38, v22, v38
    v_mul_f32 v39, v22, v39
    v_mul_f32 v40, v22, v40
    v_mul_f32 v41, v22, v41
    v_mul_f32 v42, v22, v42
    v_mul_f32 v43, v22, v43
    v_mul_f32 v44, v22, v44
    v_mul_f32 v45, v22, v45
    v_mul_f32 v46, v22, v46
    v_mul_f32 v47, v22, v47
    v_mul_f32 v48, v22, v48
    v_mul_f32 v49, v22, v49
    v_mul_f32 v50, v22, v50
    v_mul_f32 v51, v22, v51
    v_mul_f32 v52, v22, v52
    v_mul_f32 v53, v22, v53
    v_mul_f32 v54, v22, v54
    v_mul_f32 v55, v22, v55
    v_mul_f32 v56, v22, v56
    v_mul_f32 v57, v22, v57
    v_mul_f32 v58, v22, v58
    v_mul_f32 v59, v22, v59
    v_mul_f32 v60, v22, v60
    v_mul_f32 v61, v22, v61
    s_waitcnt lgkmcnt(6)
    v_mfma_f32_32x32x16_bf16 v[192:207], v[96:99], v[128:131], 0
    v_mul_f32 v62, v22, v62
    v_mul_f32 v63, v22, v63
    v_mul_f32 v64, v22, v64
    v_mul_f32 v65, v22, v65
    v_mul_f32 v66, v22, v66
    v_mul_f32 v67, v22, v67
    v_mfma_f32_32x32x16_bf16 v[208:223], v[100:103], v[128:131], 0
    ds_read_b128 v[96:99], v5 offset:16384
    ds_read_b128 v[100:103], v5 offset:24576
    v_mul_f32 v68, v22, v68
    v_mul_f32 v69, v22, v69
    v_mul_f32 v70, v22, v70
    v_mul_f32 v71, v22, v71
    v_mul_f32 v72, v22, v72
    v_mul_f32 v73, v22, v73
    s_waitcnt lgkmcnt(6)
    v_mfma_f32_32x32x16_bf16 v[192:207], v[104:107], v[132:135], v[192:207]
    v_mul_f32 v74, v22, v74
    v_mul_f32 v75, v22, v75
    v_mul_f32 v76, v22, v76
    v_mul_f32 v77, v22, v77
    v_mul_f32 v78, v22, v78
    v_mul_f32 v79, v22, v79
    v_mfma_f32_32x32x16_bf16 v[208:223], v[108:111], v[132:135], v[208:223]
    ds_read_b128 v[104:107], v6 offset:16384
    ds_read_b128 v[108:111], v6 offset:24576
    v_mul_f32 v80, v22, v80
    v_mul_f32 v81, v22, v81
    v_mul_f32 v82, v22, v82
    v_mul_f32 v83, v22, v83
    v_mul_f32 v84, v22, v84
    v_mul_f32 v85, v22, v85
    s_waitcnt lgkmcnt(6)
    v_mfma_f32_32x32x16_bf16 v[192:207], v[112:115], v[136:139], v[192:207]
    v_mul_f32 v86, v22, v86
    v_mul_f32 v87, v22, v87
    v_mul_f32 v88, v22, v88
    v_mul_f32 v89, v22, v89
    v_mul_f32 v90, v22, v90
    v_mul_f32 v91, v22, v91
    v_mfma_f32_32x32x16_bf16 v[208:223], v[116:119], v[136:139], v[208:223]
    ds_read_b128 v[112:115], v7 offset:16384
    ds_read_b128 v[116:119], v7 offset:24576
    v_mul_f32 v92, v22, v92
    v_mul_f32 v93, v22, v93
    v_mul_f32 v94, v22, v94
    v_mul_f32 v95, v22, v95
    v_exp_f32 v178, v178
    s_waitcnt lgkmcnt(6)
    v_mfma_f32_32x32x16_bf16 v[192:207], v[120:123], v[140:143], v[192:207]
    v_exp_f32 v179, v179
    v_exp_f32 v180, v180
    v_exp_f32 v181, v181
    v_mfma_f32_32x32x16_bf16 v[208:223], v[124:127], v[140:143], v[208:223]
    ds_read_b128 v[120:123], v8 offset:16384
    ds_read_b128 v[124:127], v8 offset:24576
    v_exp_f32 v182, v182
    v_exp_f32 v183, v183
    v_add_f32 v21, v21, v176
    v_add_f32 v26, v26, v177
    s_waitcnt lgkmcnt(6)
    v_mfma_f32_32x32x16_bf16 v[192:207], v[96:99], v[144:147], v[192:207]
    v_add_f32 v21, v21, v178
    v_add_f32 v26, v26, v179
    v_add_f32 v21, v21, v180
    v_add_f32 v26, v26, v181
    v_add_f32 v21, v21, v182
    v_add_f32 v26, v26, v183
    v_mfma_f32_32x32x16_bf16 v[208:223], v[100:103], v[144:147], v[208:223]
    v_cvt_pk_bf16_f32 v232, v176, v177
    v_cvt_pk_bf16_f32 v233, v178, v179
    v_cvt_pk_bf16_f32 v234, v180, v181
    v_cvt_pk_bf16_f32 v235, v182, v183
    v_fma_f32 v184, v184, s50, -v23
    v_fma_f32 v185, v185, s50, -v23
    s_waitcnt lgkmcnt(4)
    v_mfma_f32_32x32x16_bf16 v[192:207], v[104:107], v[148:151], v[192:207]
    v_fma_f32 v186, v186, s50, -v23
    v_fma_f32 v187, v187, s50, -v23
    v_fma_f32 v188, v188, s50, -v23
    v_fma_f32 v189, v189, s50, -v23
    v_fma_f32 v190, v190, s50, -v23
    v_fma_f32 v191, v191, s50, -v23
    v_mfma_f32_32x32x16_bf16 v[208:223], v[108:111], v[148:151], v[208:223]
    v_exp_f32 v184, v184
    v_exp_f32 v185, v185
    v_exp_f32 v186, v186
    s_waitcnt lgkmcnt(2)
    v_mfma_f32_32x32x16_bf16 v[192:207], v[112:115], v[152:155], v[192:207]
    v_exp_f32 v187, v187
    v_exp_f32 v188, v188
    v_exp_f32 v189, v189
    v_mfma_f32_32x32x16_bf16 v[208:223], v[116:119], v[152:155], v[208:223]
    v_exp_f32 v190, v190
    v_exp_f32 v191, v191
    v_add_f32 v21, v21, v184
    v_add_f32 v26, v26, v185
    s_waitcnt lgkmcnt(0)
    v_mfma_f32_32x32x16_bf16 v[192:207], v[120:123], v[156:159], v[192:207]
    v_add_f32 v21, v21, v186
    v_add_f32 v26, v26, v187
    v_add_f32 v21, v21, v188
    v_add_f32 v26, v26, v189
    v_add_f32 v21, v21, v190
    v_add_f32 v26, v26, v191
    v_mfma_f32_32x32x16_bf16 v[208:223], v[124:127], v[156:159], v[208:223]
    v_cvt_pk_bf16_f32 v236, v184, v185
    v_cvt_pk_bf16_f32 v237, v186, v187
    v_cvt_pk_bf16_f32 v238, v188, v189
    v_cvt_pk_bf16_f32 v239, v190, v191
    v_add_f32 v21, v21, v26
    s_waitcnt lgkmcnt(0)
    s_barrier
    ds_read_b64_tr_b16 v[96:97], v9 offset:32768
    ds_read_b64_tr_b16 v[98:99], v9 offset:34816
    ds_read_b64_tr_b16 v[100:101], v10 offset:32768
    ds_read_b64_tr_b16 v[102:103], v10 offset:34816
    ds_read_b64_tr_b16 v[104:105], v11 offset:32768
    ds_read_b64_tr_b16 v[106:107], v11 offset:34816
    ds_read_b64_tr_b16 v[108:109], v12 offset:32768
    ds_read_b64_tr_b16 v[110:111], v12 offset:34816
    ds_read_b64_tr_b16 v[112:113], v9 offset:36864
    ds_read_b64_tr_b16 v[114:115], v9 offset:38912
    ds_read_b64_tr_b16 v[116:117], v10 offset:36864
    ds_read_b64_tr_b16 v[118:119], v10 offset:38912
    v_max3_f32 v24, v192, v193, v194
    v_max3_f32 v25, v195, v196, v197
    v_max3_f32 v24, v24, v198, v199
    v_max3_f32 v25, v25, v200, v201
    v_max3_f32 v24, v24, v202, v203
    v_max3_f32 v25, v25, v204, v205
    v_max3_f32 v24, v24, v206, v207
    v_max3_f32 v25, v25, v208, v209
    v_max3_f32 v24, v24, v210, v211
    v_max3_f32 v25, v25, v212, v213
    v_max3_f32 v24, v24, v214, v215
    v_max3_f32 v25, v25, v216, v217
    v_max3_f32 v24, v24, v218, v219
    v_max3_f32 v25, v25, v220, v221
    v_max3_f32 v24, v24, v222, v223
    v_max_f32 v24, v24, v25
    v_mov_b32 v25, v24
    s_nop 1
    v_permlane32_swap_b32 v24, v25
    v_max3_f32 v24, v24, v25, v20
    v_sub_f32 v25, v20, v24
    v_mul_f32 v25, s50, v25
    v_exp_f32 v22, v25
    v_mov_b32 v20, v24
    v_mul_f32 v23, s50, v20
    v_fma_f32 v192, v192, s50, -v23
    v_fma_f32 v193, v193, s50, -v23
    v_fma_f32 v194, v194, s50, -v23
    v_fma_f32 v195, v195, s50, -v23
    v_fma_f32 v196, v196, s50, -v23
    s_waitcnt lgkmcnt(8)
    v_mfma_f32_32x32x16_bf16 v[32:47], v[96:99], v[224:227], v[32:47]
    v_fma_f32 v197, v197, s50, -v23
    v_fma_f32 v198, v198, s50, -v23
    v_fma_f32 v199, v199, s50, -v23
    v_exp_f32 v192, v192
    v_mfma_f32_32x32x16_bf16 v[48:63], v[100:103], v[224:227], v[48:63]
    ds_read_b64_tr_b16 v[120:121], v11 offset:36864
    ds_read_b64_tr_b16 v[122:123], v11 offset:38912
    ds_read_b64_tr_b16 v[124:125], v12 offset:36864
    ds_read_b64_tr_b16 v[126:127], v12 offset:38912
    v_exp_f32 v193, v193
    v_exp_f32 v194, v194
    v_exp_f32 v195, v195
    s_waitcnt lgkmcnt(8)
    v_mfma_f32_32x32x16_bf16 v[64:79], v[104:107], v[224:227], v[64:79]
    v_exp_f32 v196, v196
    v_exp_f32 v197, v197
    v_mfma_f32_32x32x16_bf16 v[80:95], v[108:111], v[224:227], v[80:95]
    ds_read_b64_tr_b16 v[96:97], v9 offset:40960
    ds_read_b64_tr_b16 v[98:99], v9 offset:43008
    ds_read_b64_tr_b16 v[100:101], v10 offset:40960
    ds_read_b64_tr_b16 v[102:103], v10 offset:43008
    v_exp_f32 v198, v198
    v_exp_f32 v199, v199
    v_fma_f32 v21, v21, v22, v192
    s_waitcnt lgkmcnt(8)
    v_mfma_f32_32x32x16_bf16 v[32:47], v[112:115], v[228:231], v[32:47]
    v_mov_b32 v26, v193
    v_add_f32 v21, v21, v194
    v_add_f32 v26, v26, v195
    v_add_f32 v21, v21, v196
    v_add_f32 v26, v26, v197
    v_mfma_f32_32x32x16_bf16 v[48:63], v[116:119], v[228:231], v[48:63]
    ds_read_b64_tr_b16 v[104:105], v11 offset:40960
    ds_read_b64_tr_b16 v[106:107], v11 offset:43008
    ds_read_b64_tr_b16 v[108:109], v12 offset:40960
    ds_read_b64_tr_b16 v[110:111], v12 offset:43008
    v_add_f32 v21, v21, v198
    v_add_f32 v26, v26, v199
    v_cvt_pk_bf16_f32 v240, v192, v193
    v_cvt_pk_bf16_f32 v241, v194, v195
    v_cvt_pk_bf16_f32 v242, v196, v197
    s_waitcnt lgkmcnt(8)
    v_mfma_f32_32x32x16_bf16 v[64:79], v[120:123], v[228:231], v[64:79]
    v_cvt_pk_bf16_f32 v243, v198, v199
    v_fma_f32 v200, v200, s50, -v23
    v_fma_f32 v201, v201, s50, -v23
    v_fma_f32 v202, v202, s50, -v23
    v_fma_f32 v203, v203, s50, -v23
    v_mfma_f32_32x32x16_bf16 v[80:95], v[124:127], v[228:231], v[80:95]
    ds_read_b64_tr_b16 v[112:113], v9 offset:45056
    ds_read_b64_tr_b16 v[114:115], v9 offset:47104
    ds_read_b64_tr_b16 v[116:117], v10 offset:45056
    ds_read_b64_tr_b16 v[118:119], v10 offset:47104
    v_fma_f32 v204, v204, s50, -v23
    v_fma_f32 v205, v205, s50, -v23
    v_fma_f32 v206, v206, s50, -v23
    v_fma_f32 v207, v207, s50, -v23
    v_exp_f32 v200, v200
    s_waitcnt lgkmcnt(8)
    v_mfma_f32_32x32x16_bf16 v[32:47], v[96:99], v[232:235], v[32:47]
    v_exp_f32 v201, v201
    v_exp_f32 v202, v202
    v_mfma_f32_32x32x16_bf16 v[48:63], v[100:103], v[232:235], v[48:63]
    ds_read_b64_tr_b16 v[120:121], v11 offset:45056
    ds_read_b64_tr_b16 v[122:123], v11 offset:47104
    ds_read_b64_tr_b16 v[124:125], v12 offset:45056
    ds_read_b64_tr_b16 v[126:127], v12 offset:47104
    v_exp_f32 v203, v203
    v_exp_f32 v204, v204
    v_exp_f32 v205, v205
    s_waitcnt lgkmcnt(8)
    v_mfma_f32_32x32x16_bf16 v[64:79], v[104:107], v[232:235], v[64:79]
    v_exp_f32 v206, v206
    v_exp_f32 v207, v207
    v_mfma_f32_32x32x16_bf16 v[80:95], v[108:111], v[232:235], v[80:95]
    v_add_f32 v21, v21, v200
    v_add_f32 v26, v26, v201
    v_add_f32 v21, v21, v202
    v_add_f32 v26, v26, v203
    v_add_f32 v21, v21, v204
    s_waitcnt lgkmcnt(4)
    v_mfma_f32_32x32x16_bf16 v[32:47], v[112:115], v[236:239], v[32:47]
    v_add_f32 v26, v26, v205
    v_add_f32 v21, v21, v206
    v_add_f32 v26, v26, v207
    v_cvt_pk_bf16_f32 v244, v200, v201
    v_cvt_pk_bf16_f32 v245, v202, v203
    v_mfma_f32_32x32x16_bf16 v[48:63], v[116:119], v[236:239], v[48:63]
    v_cvt_pk_bf16_f32 v246, v204, v205
    v_cvt_pk_bf16_f32 v247, v206, v207
    v_fma_f32 v208, v208, s50, -v23
    v_fma_f32 v209, v209, s50, -v23
    v_fma_f32 v210, v210, s50, -v23
    s_waitcnt lgkmcnt(0)
    v_mfma_f32_32x32x16_bf16 v[64:79], v[120:123], v[236:239], v[64:79]
    v_fma_f32 v211, v211, s50, -v23
    v_fma_f32 v212, v212, s50, -v23
    v_fma_f32 v213, v213, s50, -v23
    v_fma_f32 v214, v214, s50, -v23
    v_fma_f32 v215, v215, s50, -v23
    v_mfma_f32_32x32x16_bf16 v[80:95], v[124:127], v[236:239], v[80:95]
    v_exp_f32 v208, v208
    v_exp_f32 v209, v209
    s_waitcnt lgkmcnt(0)
    s_barrier
    ds_read_b128 v[96:99], v1 offset:49152
    ds_read_b128 v[100:103], v1 offset:57344
    ds_read_b128 v[104:107], v2 offset:49152
    ds_read_b128 v[108:111], v2 offset:57344
    ds_read_b128 v[112:115], v3 offset:49152
    ds_read_b128 v[116:119], v3 offset:57344
    ds_read_b128 v[120:123], v4 offset:49152
    ds_read_b128 v[124:127], v4 offset:57344
    v_mul_f32 v32, v22, v32
    v_mul_f32 v33, v22, v33
    v_mul_f32 v34, v22, v34
    v_mul_f32 v35, v22, v35
    v_mul_f32 v36, v22, v36
    v_mul_f32 v37, v22, v37
    v_mul_f32 v38, v22, v38
    v_mul_f32 v39, v22, v39
    v_mul_f32 v40, v22, v40
    v_mul_f32 v41, v22, v41
    v_mul_f32 v42, v22, v42
    v_mul_f32 v43, v22, v43
    v_mul_f32 v44, v22, v44
    v_mul_f32 v45, v22, v45
    v_mul_f32 v46, v22, v46
    v_mul_f32 v47, v22, v47
    v_mul_f32 v48, v22, v48
    v_mul_f32 v49, v22, v49
    v_mul_f32 v50, v22, v50
    v_mul_f32 v51, v22, v51
    v_mul_f32 v52, v22, v52
    v_mul_f32 v53, v22, v53
    v_mul_f32 v54, v22, v54
    v_mul_f32 v55, v22, v55
    v_mul_f32 v56, v22, v56
    v_mul_f32 v57, v22, v57
    v_mul_f32 v58, v22, v58
    v_mul_f32 v59, v22, v59
    v_mul_f32 v60, v22, v60
    v_mul_f32 v61, v22, v61
    s_waitcnt lgkmcnt(6)
    v_mfma_f32_32x32x16_bf16 v[160:175], v[96:99], v[128:131], 0
    v_mul_f32 v62, v22, v62
    v_mul_f32 v63, v22, v63
    v_mul_f32 v64, v22, v64
    v_mul_f32 v65, v22, v65
    v_mul_f32 v66, v22, v66
    v_mul_f32 v67, v22, v67
    v_mfma_f32_32x32x16_bf16 v[176:191], v[100:103], v[128:131], 0
    ds_read_b128 v[96:99], v5 offset:49152
    ds_read_b128 v[100:103], v5 offset:57344
    v_mul_f32 v68, v22, v68
    v_mul_f32 v69, v22, v69
    v_mul_f32 v70, v22, v70
    v_mul_f32 v71, v22, v71
    v_mul_f32 v72, v22, v72
    v_mul_f32 v73, v22, v73
    s_waitcnt lgkmcnt(6)
    v_mfma_f32_32x32x16_bf16 v[160:175], v[104:107], v[132:135], v[160:175]
    v_mul_f32 v74, v22, v74
    v_mul_f32 v75, v22, v75
    v_mul_f32 v76, v22, v76
    v_mul_f32 v77, v22, v77
    v_mul_f32 v78, v22, v78
    v_mul_f32 v79, v22, v79
    v_mfma_f32_32x32x16_bf16 v[176:191], v[108:111], v[132:135], v[176:191]
    ds_read_b128 v[104:107], v6 offset:49152
    ds_read_b128 v[108:111], v6 offset:57344
    v_mul_f32 v80, v22, v80
    v_mul_f32 v81, v22, v81
    v_mul_f32 v82, v22, v82
    v_mul_f32 v83, v22, v83
    v_mul_f32 v84, v22, v84
    v_mul_f32 v85, v22, v85
    s_waitcnt lgkmcnt(6)
    v_mfma_f32_32x32x16_bf16 v[160:175], v[112:115], v[136:139], v[160:175]
    v_mul_f32 v86, v22, v86
    v_mul_f32 v87, v22, v87
    v_mul_f32 v88, v22, v88
    v_mul_f32 v89, v22, v89
    v_mul_f32 v90, v22, v90
    v_mul_f32 v91, v22, v91
    v_mfma_f32_32x32x16_bf16 v[176:191], v[116:119], v[136:139], v[176:191]
    ds_read_b128 v[112:115], v7 offset:49152
    ds_read_b128 v[116:119], v7 offset:57344
    v_mul_f32 v92, v22, v92
    v_mul_f32 v93, v22, v93
    v_mul_f32 v94, v22, v94
    v_mul_f32 v95, v22, v95
    v_exp_f32 v210, v210
    s_waitcnt lgkmcnt(6)
    v_mfma_f32_32x32x16_bf16 v[160:175], v[120:123], v[140:143], v[160:175]
    v_exp_f32 v211, v211
    v_exp_f32 v212, v212
    v_exp_f32 v213, v213
    v_mfma_f32_32x32x16_bf16 v[176:191], v[124:127], v[140:143], v[176:191]
    ds_read_b128 v[120:123], v8 offset:49152
    ds_read_b128 v[124:127], v8 offset:57344
    v_exp_f32 v214, v214
    v_exp_f32 v215, v215
    v_add_f32 v21, v21, v208
    v_add_f32 v26, v26, v209
    s_waitcnt lgkmcnt(6)
    v_mfma_f32_32x32x16_bf16 v[160:175], v[96:99], v[144:147], v[160:175]
    v_add_f32 v21, v21, v210
    v_add_f32 v26, v26, v211
    v_add_f32 v21, v21, v212
    v_add_f32 v26, v26, v213
    v_add_f32 v21, v21, v214
    v_add_f32 v26, v26, v215
    v_mfma_f32_32x32x16_bf16 v[176:191], v[100:103], v[144:147], v[176:191]
    v_cvt_pk_bf16_f32 v248, v208, v209
    v_cvt_pk_bf16_f32 v249, v210, v211
    v_cvt_pk_bf16_f32 v250, v212, v213
    v_cvt_pk_bf16_f32 v251, v214, v215
    v_fma_f32 v216, v216, s50, -v23
    v_fma_f32 v217, v217, s50, -v23
    s_waitcnt lgkmcnt(4)
    v_mfma_f32_32x32x16_bf16 v[160:175], v[104:107], v[148:151], v[160:175]
    v_fma_f32 v218, v218, s50, -v23
    v_fma_f32 v219, v219, s50, -v23
    v_fma_f32 v220, v220, s50, -v23
    v_fma_f32 v221, v221, s50, -v23
    v_fma_f32 v222, v222, s50, -v23
    v_fma_f32 v223, v223, s50, -v23
    v_mfma_f32_32x32x16_bf16 v[176:191], v[108:111], v[148:151], v[176:191]
    v_exp_f32 v216, v216
    v_exp_f32 v217, v217
    v_exp_f32 v218, v218
    s_waitcnt lgkmcnt(2)
    v_mfma_f32_32x32x16_bf16 v[160:175], v[112:115], v[152:155], v[160:175]
    v_exp_f32 v219, v219
    v_exp_f32 v220, v220
    v_exp_f32 v221, v221
    v_mfma_f32_32x32x16_bf16 v[176:191], v[116:119], v[152:155], v[176:191]
    v_exp_f32 v222, v222
    v_exp_f32 v223, v223
    v_add_f32 v21, v21, v216
    v_add_f32 v26, v26, v217
    s_waitcnt lgkmcnt(0)
    v_mfma_f32_32x32x16_bf16 v[160:175], v[120:123], v[156:159], v[160:175]
    v_add_f32 v21, v21, v218
    v_add_f32 v26, v26, v219
    v_add_f32 v21, v21, v220
    v_add_f32 v26, v26, v221
    v_add_f32 v21, v21, v222
    v_add_f32 v26, v26, v223
    v_mfma_f32_32x32x16_bf16 v[176:191], v[124:127], v[156:159], v[176:191]
    v_cvt_pk_bf16_f32 v252, v216, v217
    v_cvt_pk_bf16_f32 v253, v218, v219
    v_cvt_pk_bf16_f32 v254, v220, v221
    v_cvt_pk_bf16_f32 v255, v222, v223
    v_add_f32 v21, v21, v26
    s_waitcnt lgkmcnt(0)
    s_barrier
    v_add_u32 v1, 65536, v1
    v_add_u32 v2, 65536, v2
    v_add_u32 v3, 65536, v3
    v_add_u32 v4, 65536, v4
    v_add_u32 v5, 65536, v5
    v_add_u32 v6, 65536, v6
    v_add_u32 v7, 65536, v7
    v_add_u32 v8, 65536, v8
    v_add_u32 v9, 65536, v9
    v_add_u32 v10, 65536, v10
    v_add_u32 v11, 65536, v11
    v_add_u32 v12, 65536, v12
    ds_read_b64_tr_b16 v[96:97], v9 offset:0
    ds_read_b64_tr_b16 v[98:99], v9 offset:2048
    ds_read_b64_tr_b16 v[100:101], v10 offset:0
    ds_read_b64_tr_b16 v[102:103], v10 offset:2048
    ds_read_b64_tr_b16 v[104:105], v11 offset:0
    ds_read_b64_tr_b16 v[106:107], v11 offset:2048
    ds_read_b64_tr_b16 v[108:109], v12 offset:0
    ds_read_b64_tr_b16 v[110:111], v12 offset:2048
    ds_read_b64_tr_b16 v[112:113], v9 offset:4096
    ds_read_b64_tr_b16 v[114:115], v9 offset:6144
    ds_read_b64_tr_b16 v[116:117], v10 offset:4096
    ds_read_b64_tr_b16 v[118:119], v10 offset:6144
    v_max3_f32 v24, v160, v161, v162
    v_max3_f32 v25, v163, v164, v165
    v_max3_f32 v24, v24, v166, v167
    v_max3_f32 v25, v25, v168, v169
    v_max3_f32 v24, v24, v170, v171
    v_max3_f32 v25, v25, v172, v173
    v_max3_f32 v24, v24, v174, v175
    v_max3_f32 v25, v25, v176, v177
    v_max3_f32 v24, v24, v178, v179
    v_max3_f32 v25, v25, v180, v181
    v_max3_f32 v24, v24, v182, v183
    v_max3_f32 v25, v25, v184, v185
    v_max3_f32 v24, v24, v186, v187
    v_max3_f32 v25, v25, v188, v189
    v_max3_f32 v24, v24, v190, v191
    v_max_f32 v24, v24, v25
    v_mov_b32 v25, v24
    s_nop 1
    v_permlane32_swap_b32 v24, v25
    v_max3_f32 v24, v24, v25, v20
    v_sub_f32 v25, v20, v24
    v_mul_f32 v25, s50, v25
    v_exp_f32 v22, v25
    v_mov_b32 v20, v24
    v_mul_f32 v23, s50, v20
    v_fma_f32 v160, v160, s50, -v23
    v_fma_f32 v161, v161, s50, -v23
    v_fma_f32 v162, v162, s50, -v23
    v_fma_f32 v163, v163, s50, -v23
    v_fma_f32 v164, v164, s50, -v23
    s_waitcnt lgkmcnt(8)
    v_mfma_f32_32x32x16_bf16 v[32:47], v[96:99], v[240:243], v[32:47]
    v_fma_f32 v165, v165, s50, -v23
    v_fma_f32 v166, v166, s50, -v23
    v_fma_f32 v167, v167, s50, -v23
    v_exp_f32 v160, v160
    v_mfma_f32_32x32x16_bf16 v[48:63], v[100:103], v[240:243], v[48:63]
    ds_read_b64_tr_b16 v[120:121], v11 offset:4096
    ds_read_b64_tr_b16 v[122:123], v11 offset:6144
    ds_read_b64_tr_b16 v[124:125], v12 offset:4096
    ds_read_b64_tr_b16 v[126:127], v12 offset:6144
    v_exp_f32 v161, v161
    v_exp_f32 v162, v162
    v_exp_f32 v163, v163
    s_waitcnt lgkmcnt(8)
    v_mfma_f32_32x32x16_bf16 v[64:79], v[104:107], v[240:243], v[64:79]
    v_exp_f32 v164, v164
    v_exp_f32 v165, v165
    v_mfma_f32_32x32x16_bf16 v[80:95], v[108:111], v[240:243], v[80:95]
    ds_read_b64_tr_b16 v[96:97], v9 offset:8192
    ds_read_b64_tr_b16 v[98:99], v9 offset:10240
    ds_read_b64_tr_b16 v[100:101], v10 offset:8192
    ds_read_b64_tr_b16 v[102:103], v10 offset:10240
    v_exp_f32 v166, v166
    v_exp_f32 v167, v167
    v_fma_f32 v21, v21, v22, v160
    s_waitcnt lgkmcnt(8)
    v_mfma_f32_32x32x16_bf16 v[32:47], v[112:115], v[244:247], v[32:47]
    v_mov_b32 v26, v161
    v_add_f32 v21, v21, v162
    v_add_f32 v26, v26, v163
    v_add_f32 v21, v21, v164
    v_add_f32 v26, v26, v165
    v_mfma_f32_32x32x16_bf16 v[48:63], v[116:119], v[244:247], v[48:63]
    ds_read_b64_tr_b16 v[104:105], v11 offset:8192
    ds_read_b64_tr_b16 v[106:107], v11 offset:10240
    ds_read_b64_tr_b16 v[108:109], v12 offset:8192
    ds_read_b64_tr_b16 v[110:111], v12 offset:10240
    v_add_f32 v21, v21, v166
    v_add_f32 v26, v26, v167
    v_cvt_pk_bf16_f32 v224, v160, v161
    v_cvt_pk_bf16_f32 v225, v162, v163
    v_cvt_pk_bf16_f32 v226, v164, v165
    s_waitcnt lgkmcnt(8)
    v_mfma_f32_32x32x16_bf16 v[64:79], v[120:123], v[244:247], v[64:79]
    v_cvt_pk_bf16_f32 v227, v166, v167
    v_fma_f32 v168, v168, s50, -v23
    v_fma_f32 v169, v169, s50, -v23
    v_fma_f32 v170, v170, s50, -v23
    v_fma_f32 v171, v171, s50, -v23
    v_mfma_f32_32x32x16_bf16 v[80:95], v[124:127], v[244:247], v[80:95]
    ds_read_b64_tr_b16 v[112:113], v9 offset:12288
    ds_read_b64_tr_b16 v[114:115], v9 offset:14336
    ds_read_b64_tr_b16 v[116:117], v10 offset:12288
    ds_read_b64_tr_b16 v[118:119], v10 offset:14336
    v_fma_f32 v172, v172, s50, -v23
    v_fma_f32 v173, v173, s50, -v23
    v_fma_f32 v174, v174, s50, -v23
    v_fma_f32 v175, v175, s50, -v23
    v_exp_f32 v168, v168
    s_waitcnt lgkmcnt(8)
    v_mfma_f32_32x32x16_bf16 v[32:47], v[96:99], v[248:251], v[32:47]
    v_exp_f32 v169, v169
    v_exp_f32 v170, v170
    v_mfma_f32_32x32x16_bf16 v[48:63], v[100:103], v[248:251], v[48:63]
    ds_read_b64_tr_b16 v[120:121], v11 offset:12288
    ds_read_b64_tr_b16 v[122:123], v11 offset:14336
    ds_read_b64_tr_b16 v[124:125], v12 offset:12288
    ds_read_b64_tr_b16 v[126:127], v12 offset:14336
    v_exp_f32 v171, v171
    v_exp_f32 v172, v172
    v_exp_f32 v173, v173
    s_waitcnt lgkmcnt(8)
    v_mfma_f32_32x32x16_bf16 v[64:79], v[104:107], v[248:251], v[64:79]
    v_exp_f32 v174, v174
    v_exp_f32 v175, v175
    v_mfma_f32_32x32x16_bf16 v[80:95], v[108:111], v[248:251], v[80:95]
    v_add_f32 v21, v21, v168
    v_add_f32 v26, v26, v169
    v_add_f32 v21, v21, v170
    v_add_f32 v26, v26, v171
    v_add_f32 v21, v21, v172
    s_waitcnt lgkmcnt(4)
    v_mfma_f32_32x32x16_bf16 v[32:47], v[112:115], v[252:255], v[32:47]
    v_add_f32 v26, v26, v173
    v_add_f32 v21, v21, v174
    v_add_f32 v26, v26, v175
    v_cvt_pk_bf16_f32 v228, v168, v169
    v_cvt_pk_bf16_f32 v229, v170, v171
    v_mfma_f32_32x32x16_bf16 v[48:63], v[116:119], v[252:255], v[48:63]
    v_cvt_pk_bf16_f32 v230, v172, v173
    v_cvt_pk_bf16_f32 v231, v174, v175
    v_fma_f32 v176, v176, s50, -v23
    v_fma_f32 v177, v177, s50, -v23
    v_fma_f32 v178, v178, s50, -v23
    s_waitcnt lgkmcnt(0)
    v_mfma_f32_32x32x16_bf16 v[64:79], v[120:123], v[252:255], v[64:79]
    v_fma_f32 v179, v179, s50, -v23
    v_fma_f32 v180, v180, s50, -v23
    v_fma_f32 v181, v181, s50, -v23
    v_fma_f32 v182, v182, s50, -v23
    v_fma_f32 v183, v183, s50, -v23
    v_mfma_f32_32x32x16_bf16 v[80:95], v[124:127], v[252:255], v[80:95]
    v_exp_f32 v176, v176
    v_exp_f32 v177, v177
    s_waitcnt lgkmcnt(0)
    s_barrier
    ds_read_b128 v[96:99], v1 offset:16384
    ds_read_b128 v[100:103], v1 offset:24576
    ds_read_b128 v[104:107], v2 offset:16384
    ds_read_b128 v[108:111], v2 offset:24576
    ds_read_b128 v[112:115], v3 offset:16384
    ds_read_b128 v[116:119], v3 offset:24576
    ds_read_b128 v[120:123], v4 offset:16384
    ds_read_b128 v[124:127], v4 offset:24576
    v_mul_f32 v32, v22, v32
    v_mul_f32 v33, v22, v33
    v_mul_f32 v34, v22, v34
    v_mul_f32 v35, v22, v35
    v_mul_f32 v36, v22, v36
    v_mul_f32 v37, v22, v37
    v_mul_f32 v38, v22, v38
    v_mul_f32 v39, v22, v39
    v_mul_f32 v40, v22, v40
    v_mul_f32 v41, v22, v41
    v_mul_f32 v42, v22, v42
    v_mul_f32 v43, v22, v43
    v_mul_f32 v44, v22, v44
    v_mul_f32 v45, v22, v45
    v_mul_f32 v46, v22, v46
    v_mul_f32 v47, v22, v47
    v_mul_f32 v48, v22, v48
    v_mul_f32 v49, v22, v49
    v_mul_f32 v50, v22, v50
    v_mul_f32 v51, v22, v51
    v_mul_f32 v52, v22, v52
    v_mul_f32 v53, v22, v53
    v_mul_f32 v54, v22, v54
    v_mul_f32 v55, v22, v55
    v_mul_f32 v56, v22, v56
    v_mul_f32 v57, v22, v57
    v_mul_f32 v58, v22, v58
    v_mul_f32 v59, v22, v59
    v_mul_f32 v60, v22, v60
    v_mul_f32 v61, v22, v61
    s_waitcnt lgkmcnt(6)
    v_mfma_f32_32x32x16_bf16 v[192:207], v[96:99], v[128:131], 0
    v_mul_f32 v62, v22, v62
    v_mul_f32 v63, v22, v63
    v_mul_f32 v64, v22, v64
    v_mul_f32 v65, v22, v65
    v_mul_f32 v66, v22, v66
    v_mul_f32 v67, v22, v67
    v_mfma_f32_32x32x16_bf16 v[208:223], v[100:103], v[128:131], 0
    ds_read_b128 v[96:99], v5 offset:16384
    ds_read_b128 v[100:103], v5 offset:24576
    v_mul_f32 v68, v22, v68
    v_mul_f32 v69, v22, v69
    v_mul_f32 v70, v22, v70
    v_mul_f32 v71, v22, v71
    v_mul_f32 v72, v22, v72
    v_mul_f32 v73, v22, v73
    s_waitcnt lgkmcnt(6)
    v_mfma_f32_32x32x16_bf16 v[192:207], v[104:107], v[132:135], v[192:207]
    v_mul_f32 v74, v22, v74
    v_mul_f32 v75, v22, v75
    v_mul_f32 v76, v22, v76
    v_mul_f32 v77, v22, v77
    v_mul_f32 v78, v22, v78
    v_mul_f32 v79, v22, v79
    v_mfma_f32_32x32x16_bf16 v[208:223], v[108:111], v[132:135], v[208:223]
    ds_read_b128 v[104:107], v6 offset:16384
    ds_read_b128 v[108:111], v6 offset:24576
    v_mul_f32 v80, v22, v80
    v_mul_f32 v81, v22, v81
    v_mul_f32 v82, v22, v82
    v_mul_f32 v83, v22, v83
    v_mul_f32 v84, v22, v84
    v_mul_f32 v85, v22, v85
    s_waitcnt lgkmcnt(6)
    v_mfma_f32_32x32x16_bf16 v[192:207], v[112:115], v[136:139], v[192:207]
    v_mul_f32 v86, v22, v86
    v_mul_f32 v87, v22, v87
    v_mul_f32 v88, v22, v88
    v_mul_f32 v89, v22, v89
    v_mul_f32 v90, v22, v90
    v_mul_f32 v91, v22, v91
    v_mfma_f32_32x32x16_bf16 v[208:223], v[116:119], v[136:139], v[208:223]
    ds_read_b128 v[112:115], v7 offset:16384
    ds_read_b128 v[116:119], v7 offset:24576
    v_mul_f32 v92, v22, v92
    v_mul_f32 v93, v22, v93
    v_mul_f32 v94, v22, v94
    v_mul_f32 v95, v22, v95
    v_exp_f32 v178, v178
    s_waitcnt lgkmcnt(6)
    v_mfma_f32_32x32x16_bf16 v[192:207], v[120:123], v[140:143], v[192:207]
    v_exp_f32 v179, v179
    v_exp_f32 v180, v180
    v_exp_f32 v181, v181
    v_mfma_f32_32x32x16_bf16 v[208:223], v[124:127], v[140:143], v[208:223]
    ds_read_b128 v[120:123], v8 offset:16384
    ds_read_b128 v[124:127], v8 offset:24576
    v_exp_f32 v182, v182
    v_exp_f32 v183, v183
    v_add_f32 v21, v21, v176
    v_add_f32 v26, v26, v177
    s_waitcnt lgkmcnt(6)
    v_mfma_f32_32x32x16_bf16 v[192:207], v[96:99], v[144:147], v[192:207]
    v_add_f32 v21, v21, v178
    v_add_f32 v26, v26, v179
    v_add_f32 v21, v21, v180
    v_add_f32 v26, v26, v181
    v_add_f32 v21, v21, v182
    v_add_f32 v26, v26, v183
    v_mfma_f32_32x32x16_bf16 v[208:223], v[100:103], v[144:147], v[208:223]
    v_cvt_pk_bf16_f32 v232, v176, v177
    v_cvt_pk_bf16_f32 v233, v178, v179
    v_cvt_pk_bf16_f32 v234, v180, v181
    v_cvt_pk_bf16_f32 v235, v182, v183
    v_fma_f32 v184, v184, s50, -v23
    v_fma_f32 v185, v185, s50, -v23
    s_waitcnt lgkmcnt(4)
    v_mfma_f32_32x32x16_bf16 v[192:207], v[104:107], v[148:151], v[192:207]
    v_fma_f32 v186, v186, s50, -v23
    v_fma_f32 v187, v187, s50, -v23
    v_fma_f32 v188, v188, s50, -v23
    v_fma_f32 v189, v189, s50, -v23
    v_fma_f32 v190, v190, s50, -v23
    v_fma_f32 v191, v191, s50, -v23
    v_mfma_f32_32x32x16_bf16 v[208:223], v[108:111], v[148:151], v[208:223]
    v_exp_f32 v184, v184
    v_exp_f32 v185, v185
    v_exp_f32 v186, v186
    s_waitcnt lgkmcnt(2)
    v_mfma_f32_32x32x16_bf16 v[192:207], v[112:115], v[152:155], v[192:207]
    v_exp_f32 v187, v187
    v_exp_f32 v188, v188
    v_exp_f32 v189, v189
    v_mfma_f32_32x32x16_bf16 v[208:223], v[116:119], v[152:155], v[208:223]
    v_exp_f32 v190, v190
    v_exp_f32 v191, v191
    v_add_f32 v21, v21, v184
    v_add_f32 v26, v26, v185
    s_waitcnt lgkmcnt(0)
    v_mfma_f32_32x32x16_bf16 v[192:207], v[120:123], v[156:159], v[192:207]
    v_add_f32 v21, v21, v186
    v_add_f32 v26, v26, v187
    v_add_f32 v21, v21, v188
    v_add_f32 v26, v26, v189
    v_add_f32 v21, v21, v190
    v_add_f32 v26, v26, v191
    v_mfma_f32_32x32x16_bf16 v[208:223], v[124:127], v[156:159], v[208:223]
    v_cvt_pk_bf16_f32 v236, v184, v185
    v_cvt_pk_bf16_f32 v237, v186, v187
    v_cvt_pk_bf16_f32 v238, v188, v189
    v_cvt_pk_bf16_f32 v239, v190, v191
    v_add_f32 v21, v21, v26
    s_waitcnt lgkmcnt(0)
    s_barrier
    ds_read_b64_tr_b16 v[96:97], v9 offset:32768
    ds_read_b64_tr_b16 v[98:99], v9 offset:34816
    ds_read_b64_tr_b16 v[100:101], v10 offset:32768
    ds_read_b64_tr_b16 v[102:103], v10 offset:34816
    ds_read_b64_tr_b16 v[104:105], v11 offset:32768
    ds_read_b64_tr_b16 v[106:107], v11 offset:34816
    ds_read_b64_tr_b16 v[108:109], v12 offset:32768
    ds_read_b64_tr_b16 v[110:111], v12 offset:34816
    ds_read_b64_tr_b16 v[112:113], v9 offset:36864
    ds_read_b64_tr_b16 v[114:115], v9 offset:38912
    ds_read_b64_tr_b16 v[116:117], v10 offset:36864
    ds_read_b64_tr_b16 v[118:119], v10 offset:38912
    v_max3_f32 v24, v192, v193, v194
    v_max3_f32 v25, v195, v196, v197
    v_max3_f32 v24, v24, v198, v199
    v_max3_f32 v25, v25, v200, v201
    v_max3_f32 v24, v24, v202, v203
    v_max3_f32 v25, v25, v204, v205
    v_max3_f32 v24, v24, v206, v207
    v_max3_f32 v25, v25, v208, v209
    s_mov_b32 s48, 229376
    buffer_load_dwordx4 v[128:131], v17, s[40:43], s48 offen offset:0
    v_max3_f32 v24, v24, v210, v211
    v_max3_f32 v25, v25, v212, v213
    v_max3_f32 v24, v24, v214, v215
    v_max3_f32 v25, v25, v216, v217
    v_max3_f32 v24, v24, v218, v219
    v_max3_f32 v25, v25, v220, v221
    v_max3_f32 v24, v24, v222, v223
    v_max_f32 v24, v24, v25
    buffer_load_dwordx4 v[132:135], v17, s[40:43], s48 offen offset:1024
    v_mov_b32 v25, v24
    s_nop 1
    v_permlane32_swap_b32 v24, v25
    v_max3_f32 v24, v24, v25, v20
    v_sub_f32 v25, v20, v24
    v_mul_f32 v25, s50, v25
    v_exp_f32 v22, v25
    v_mov_b32 v20, v24
    s_waitcnt lgkmcnt(8)
    v_mfma_f32_32x32x16_bf16 v[32:47], v[96:99], v[224:227], v[32:47]
    v_mul_f32 v23, s50, v20
    buffer_load_dwordx4 v[136:139], v17, s[40:43], s48 offen offset:2048
    v_fma_f32 v192, v192, s50, -v23
    v_fma_f32 v193, v193, s50, -v23
    v_fma_f32 v194, v194, s50, -v23
    v_fma_f32 v195, v195, s50, -v23
    v_fma_f32 v196, v196, s50, -v23
    v_fma_f32 v197, v197, s50, -v23
    v_fma_f32 v198, v198, s50, -v23
    v_fma_f32 v199, v199, s50, -v23
    v_mfma_f32_32x32x16_bf16 v[48:63], v[100:103], v[224:227], v[48:63]
    ds_read_b64_tr_b16 v[120:121], v11 offset:36864
    ds_read_b64_tr_b16 v[122:123], v11 offset:38912
    ds_read_b64_tr_b16 v[124:125], v12 offset:36864
    ds_read_b64_tr_b16 v[126:127], v12 offset:38912
    buffer_load_dwordx4 v[140:143], v17, s[40:43], s48 offen offset:3072
    v_exp_f32 v192, v192
    v_exp_f32 v193, v193
    v_exp_f32 v194, v194
    v_exp_f32 v195, v195
    v_exp_f32 v196, v196
    s_waitcnt lgkmcnt(8)
    v_mfma_f32_32x32x16_bf16 v[64:79], v[104:107], v[224:227], v[64:79]
    v_exp_f32 v197, v197
    v_exp_f32 v198, v198
    v_exp_f32 v199, v199
    buffer_load_dwordx4 v[144:147], v18, s[40:43], s48 offen offset:0
    v_fma_f32 v21, v21, v22, v192
    v_mov_b32 v26, v193
    v_mfma_f32_32x32x16_bf16 v[80:95], v[108:111], v[224:227], v[80:95]
    ds_read_b64_tr_b16 v[96:97], v9 offset:40960
    ds_read_b64_tr_b16 v[98:99], v9 offset:43008
    ds_read_b64_tr_b16 v[100:101], v10 offset:40960
    ds_read_b64_tr_b16 v[102:103], v10 offset:43008
    v_add_f32 v21, v21, v194
    v_add_f32 v26, v26, v195
    v_add_f32 v21, v21, v196
    v_add_f32 v26, v26, v197
    v_add_f32 v21, v21, v198
    v_add_f32 v26, v26, v199
    buffer_load_dwordx4 v[148:151], v18, s[40:43], s48 offen offset:1024
    v_cvt_pk_bf16_f32 v240, v192, v193
    v_cvt_pk_bf16_f32 v241, v194, v195
    s_waitcnt lgkmcnt(8)
    v_mfma_f32_32x32x16_bf16 v[32:47], v[112:115], v[228:231], v[32:47]
    v_cvt_pk_bf16_f32 v242, v196, v197
    v_cvt_pk_bf16_f32 v243, v198, v199
    v_fma_f32 v200, v200, s50, -v23
    v_fma_f32 v201, v201, s50, -v23
    v_fma_f32 v202, v202, s50, -v23
    v_fma_f32 v203, v203, s50, -v23
    buffer_load_dwordx4 v[152:155], v18, s[40:43], s48 offen offset:2048
    v_fma_f32 v204, v204, s50, -v23
    v_fma_f32 v205, v205, s50, -v23
    v_fma_f32 v206, v206, s50, -v23
    v_mfma_f32_32x32x16_bf16 v[48:63], v[116:119], v[228:231], v[48:63]
    ds_read_b64_tr_b16 v[104:105], v11 offset:40960
    ds_read_b64_tr_b16 v[106:107], v11 offset:43008
    ds_read_b64_tr_b16 v[108:109], v12 offset:40960
    ds_read_b64_tr_b16 v[110:111], v12 offset:43008
    v_fma_f32 v207, v207, s50, -v23
    v_exp_f32 v200, v200
    v_exp_f32 v201, v201
    v_exp_f32 v202, v202
    v_exp_f32 v203, v203
    buffer_load_dwordx4 v[156:159], v18, s[40:43], s48 offen offset:3072
    s_waitcnt lgkmcnt(8)
    v_mfma_f32_32x32x16_bf16 v[64:79], v[120:123], v[228:231], v[64:79]
    v_exp_f32 v204, v204
    v_exp_f32 v205, v205
    v_exp_f32 v206, v206
    v_exp_f32 v207, v207
    v_add_f32 v21, v21, v200
    v_add_f32 v26, v26, v201
    v_add_f32 v21, v21, v202
    v_add_f32 v26, v26, v203
    v_mfma_f32_32x32x16_bf16 v[80:95], v[124:127], v[228:231], v[80:95]
    ds_read_b64_tr_b16 v[112:113], v9 offset:45056
    ds_read_b64_tr_b16 v[114:115], v9 offset:47104
    ds_read_b64_tr_b16 v[116:117], v10 offset:45056
    ds_read_b64_tr_b16 v[118:119], v10 offset:47104
    s_mov_b32 s48, 262144
    buffer_load_dwordx4 v[160:163], v17, s[40:43], s48 offen offset:0
    v_add_f32 v21, v21, v204
    v_add_f32 v26, v26, v205
    v_add_f32 v21, v21, v206
    v_add_f32 v26, v26, v207
    v_cvt_pk_bf16_f32 v244, v200, v201
    v_cvt_pk_bf16_f32 v245, v202, v203
    v_cvt_pk_bf16_f32 v246, v204, v205
    v_cvt_pk_bf16_f32 v247, v206, v207
    s_waitcnt lgkmcnt(8)
    v_mfma_f32_32x32x16_bf16 v[32:47], v[96:99], v[232:235], v[32:47]
    buffer_load_dwordx4 v[164:167], v17, s[40:43], s48 offen offset:1024
    v_fma_f32 v208, v208, s50, -v23
    v_fma_f32 v209, v209, s50, -v23
    v_fma_f32 v210, v210, s50, -v23
    v_fma_f32 v211, v211, s50, -v23
    v_fma_f32 v212, v212, s50, -v23
    v_fma_f32 v213, v213, s50, -v23
    v_fma_f32 v214, v214, s50, -v23
    v_fma_f32 v215, v215, s50, -v23
    buffer_load_dwordx4 v[168:171], v17, s[40:43], s48 offen offset:2048
    v_mfma_f32_32x32x16_bf16 v[48:63], v[100:103], v[232:235], v[48:63]
    ds_read_b64_tr_b16 v[120:121], v11 offset:45056
    ds_read_b64_tr_b16 v[122:123], v11 offset:47104
    ds_read_b64_tr_b16 v[124:125], v12 offset:45056
    ds_read_b64_tr_b16 v[126:127], v12 offset:47104
    v_exp_f32 v208, v208
    v_exp_f32 v209, v209
    v_exp_f32 v210, v210
    v_exp_f32 v211, v211
    v_exp_f32 v212, v212
    s_waitcnt lgkmcnt(8)
    v_mfma_f32_32x32x16_bf16 v[64:79], v[104:107], v[232:235], v[64:79]
    v_exp_f32 v213, v213
    v_exp_f32 v214, v214
    v_exp_f32 v215, v215
    buffer_load_dwordx4 v[172:175], v17, s[40:43], s48 offen offset:3072
    v_add_f32 v21, v21, v208
    v_add_f32 v26, v26, v209
    v_add_f32 v21, v21, v210
    v_mfma_f32_32x32x16_bf16 v[80:95], v[108:111], v[232:235], v[80:95]
    v_add_f32 v26, v26, v211
    v_add_f32 v21, v21, v212
    v_add_f32 v26, v26, v213
    v_add_f32 v21, v21, v214
    v_add_f32 v26, v26, v215
    buffer_load_dwordx4 v[176:179], v18, s[40:43], s48 offen offset:0
    v_cvt_pk_bf16_f32 v248, v208, v209
    v_cvt_pk_bf16_f32 v249, v210, v211
    v_cvt_pk_bf16_f32 v250, v212, v213
    s_waitcnt lgkmcnt(4)
    v_mfma_f32_32x32x16_bf16 v[32:47], v[112:115], v[236:239], v[32:47]
    v_cvt_pk_bf16_f32 v251, v214, v215
    v_fma_f32 v216, v216, s50, -v23
    v_fma_f32 v217, v217, s50, -v23
    v_fma_f32 v218, v218, s50, -v23
    v_fma_f32 v219, v219, s50, -v23
    buffer_load_dwordx4 v[180:183], v18, s[40:43], s48 offen offset:1024
    v_fma_f32 v220, v220, s50, -v23
    v_fma_f32 v221, v221, s50, -v23
    v_fma_f32 v222, v222, s50, -v23
    v_fma_f32 v223, v223, s50, -v23
    v_mfma_f32_32x32x16_bf16 v[48:63], v[116:119], v[236:239], v[48:63]
    v_exp_f32 v216, v216
    v_exp_f32 v217, v217
    v_exp_f32 v218, v218
    v_exp_f32 v219, v219
    buffer_load_dwordx4 v[184:187], v18, s[40:43], s48 offen offset:2048
    v_exp_f32 v220, v220
    s_waitcnt lgkmcnt(0)
    v_mfma_f32_32x32x16_bf16 v[64:79], v[120:123], v[236:239], v[64:79]
    v_exp_f32 v221, v221
    v_exp_f32 v222, v222
    v_exp_f32 v223, v223
    v_add_f32 v21, v21, v216
    v_add_f32 v26, v26, v217
    v_add_f32 v21, v21, v218
    v_add_f32 v26, v26, v219
    buffer_load_dwordx4 v[188:191], v18, s[40:43], s48 offen offset:3072
    v_mfma_f32_32x32x16_bf16 v[80:95], v[124:127], v[236:239], v[80:95]
    v_add_f32 v21, v21, v220
    v_add_f32 v26, v26, v221
    v_add_f32 v21, v21, v222
    v_add_f32 v26, v26, v223
    v_cvt_pk_bf16_f32 v252, v216, v217
    v_cvt_pk_bf16_f32 v253, v218, v219
    v_cvt_pk_bf16_f32 v254, v220, v221
    v_cvt_pk_bf16_f32 v255, v222, v223
    v_add_f32 v21, v21, v26
    s_waitcnt lgkmcnt(0)
    s_barrier
    ds_read_b64_tr_b16 v[96:97], v9 offset:49152
    ds_read_b64_tr_b16 v[98:99], v9 offset:51200
    ds_read_b64_tr_b16 v[100:101], v10 offset:49152
    ds_read_b64_tr_b16 v[102:103], v10 offset:51200
    ds_read_b64_tr_b16 v[104:105], v11 offset:49152
    ds_read_b64_tr_b16 v[106:107], v11 offset:51200
    ds_read_b64_tr_b16 v[108:109], v12 offset:49152
    ds_read_b64_tr_b16 v[110:111], v12 offset:51200
    ds_read_b64_tr_b16 v[112:113], v9 offset:53248
    ds_read_b64_tr_b16 v[114:115], v9 offset:55296
    ds_read_b64_tr_b16 v[116:117], v10 offset:53248
    ds_read_b64_tr_b16 v[118:119], v10 offset:55296
    s_mov_b32 s48, 294912
    buffer_load_dwordx4 v[192:195], v17, s[40:43], s48 offen offset:0
    buffer_load_dwordx4 v[196:199], v17, s[40:43], s48 offen offset:1024
    buffer_load_dwordx4 v[200:203], v17, s[40:43], s48 offen offset:2048
    buffer_load_dwordx4 v[204:207], v17, s[40:43], s48 offen offset:3072
    buffer_load_dwordx4 v[208:211], v18, s[40:43], s48 offen offset:0
    buffer_load_dwordx4 v[212:215], v18, s[40:43], s48 offen offset:1024
    buffer_load_dwordx4 v[216:219], v18, s[40:43], s48 offen offset:2048
    buffer_load_dwordx4 v[220:223], v18, s[40:43], s48 offen offset:3072
    s_waitcnt lgkmcnt(8)
    v_mul_f32 v32, v22, v32
    v_mul_f32 v33, v22, v33
    v_mul_f32 v34, v22, v34
    v_mul_f32 v35, v22, v35
    v_mul_f32 v36, v22, v36
    v_mul_f32 v37, v22, v37
    v_mul_f32 v38, v22, v38
    v_mul_f32 v39, v22, v39
    v_mul_f32 v40, v22, v40
    v_mul_f32 v41, v22, v41
    v_mul_f32 v42, v22, v42
    v_mul_f32 v43, v22, v43
    v_mul_f32 v44, v22, v44
    v_mul_f32 v45, v22, v45
    v_mul_f32 v46, v22, v46
    v_mul_f32 v47, v22, v47
    v_mul_f32 v48, v22, v48
    v_mul_f32 v49, v22, v49
    v_mul_f32 v50, v22, v50
    v_mul_f32 v51, v22, v51
    v_mul_f32 v52, v22, v52
    v_mul_f32 v53, v22, v53
    v_mul_f32 v54, v22, v54
    v_mul_f32 v55, v22, v55
    v_mul_f32 v56, v22, v56
    v_mul_f32 v57, v22, v57
    v_mul_f32 v58, v22, v58
    v_mul_f32 v59, v22, v59
    v_mul_f32 v60, v22, v60
    v_mul_f32 v61, v22, v61
    v_mul_f32 v62, v22, v62
    v_mul_f32 v63, v22, v63
    v_mul_f32 v64, v22, v64
    v_mul_f32 v65, v22, v65
    v_mul_f32 v66, v22, v66
    v_mul_f32 v67, v22, v67
    v_mul_f32 v68, v22, v68
    v_mul_f32 v69, v22, v69
    v_mul_f32 v70, v22, v70
    v_mul_f32 v71, v22, v71
    v_mul_f32 v72, v22, v72
    v_mul_f32 v73, v22, v73
    v_mul_f32 v74, v22, v74
    v_mul_f32 v75, v22, v75
    v_mul_f32 v76, v22, v76
    v_mul_f32 v77, v22, v77
    v_mul_f32 v78, v22, v78
    v_mul_f32 v79, v22, v79
    v_mul_f32 v80, v22, v80
    v_mul_f32 v81, v22, v81
    v_mul_f32 v82, v22, v82
    v_mul_f32 v83, v22, v83
    v_mul_f32 v84, v22, v84
    v_mul_f32 v85, v22, v85
    v_mul_f32 v86, v22, v86
    v_mul_f32 v87, v22, v87
    v_mul_f32 v88, v22, v88
    v_mul_f32 v89, v22, v89
    v_mul_f32 v90, v22, v90
    v_mul_f32 v91, v22, v91
    v_mul_f32 v92, v22, v92
    v_mul_f32 v93, v22, v93
    v_mul_f32 v94, v22, v94
    v_mul_f32 v95, v22, v95
    v_mfma_f32_32x32x16_bf16 v[32:47], v[96:99], v[240:243], v[32:47]
    v_mfma_f32_32x32x16_bf16 v[48:63], v[100:103], v[240:243], v[48:63]
    ds_read_b64_tr_b16 v[120:121], v11 offset:53248
    ds_read_b64_tr_b16 v[122:123], v11 offset:55296
    ds_read_b64_tr_b16 v[124:125], v12 offset:53248
    ds_read_b64_tr_b16 v[126:127], v12 offset:55296
    s_waitcnt lgkmcnt(8)
    v_mfma_f32_32x32x16_bf16 v[64:79], v[104:107], v[240:243], v[64:79]
    v_mfma_f32_32x32x16_bf16 v[80:95], v[108:111], v[240:243], v[80:95]
    ds_read_b64_tr_b16 v[96:97], v9 offset:57344
    ds_read_b64_tr_b16 v[98:99], v9 offset:59392
    ds_read_b64_tr_b16 v[100:101], v10 offset:57344
    ds_read_b64_tr_b16 v[102:103], v10 offset:59392
    s_waitcnt lgkmcnt(8)
    v_mfma_f32_32x32x16_bf16 v[32:47], v[112:115], v[244:247], v[32:47]
    v_mfma_f32_32x32x16_bf16 v[48:63], v[116:119], v[244:247], v[48:63]
    ds_read_b64_tr_b16 v[104:105], v11 offset:57344
    ds_read_b64_tr_b16 v[106:107], v11 offset:59392
    ds_read_b64_tr_b16 v[108:109], v12 offset:57344
    ds_read_b64_tr_b16 v[110:111], v12 offset:59392
    s_waitcnt lgkmcnt(8)
    v_mfma_f32_32x32x16_bf16 v[64:79], v[120:123], v[244:247], v[64:79]
    v_mfma_f32_32x32x16_bf16 v[80:95], v[124:127], v[244:247], v[80:95]
    ds_read_b64_tr_b16 v[112:113], v9 offset:61440
    ds_read_b64_tr_b16 v[114:115], v9 offset:63488
    ds_read_b64_tr_b16 v[116:117], v10 offset:61440
    ds_read_b64_tr_b16 v[118:119], v10 offset:63488
    s_waitcnt lgkmcnt(8)
    v_mfma_f32_32x32x16_bf16 v[32:47], v[96:99], v[248:251], v[32:47]
    v_mfma_f32_32x32x16_bf16 v[48:63], v[100:103], v[248:251], v[48:63]
    ds_read_b64_tr_b16 v[120:121], v11 offset:61440
    ds_read_b64_tr_b16 v[122:123], v11 offset:63488
    ds_read_b64_tr_b16 v[124:125], v12 offset:61440
    ds_read_b64_tr_b16 v[126:127], v12 offset:63488
    s_waitcnt lgkmcnt(8)
    v_mfma_f32_32x32x16_bf16 v[64:79], v[104:107], v[248:251], v[64:79]
    v_mfma_f32_32x32x16_bf16 v[80:95], v[108:111], v[248:251], v[80:95]
    s_waitcnt lgkmcnt(4)
    v_mfma_f32_32x32x16_bf16 v[32:47], v[112:115], v[252:255], v[32:47]
    v_mfma_f32_32x32x16_bf16 v[48:63], v[116:119], v[252:255], v[48:63]
    s_waitcnt lgkmcnt(0)
    v_mfma_f32_32x32x16_bf16 v[64:79], v[120:123], v[252:255], v[64:79]
    v_mfma_f32_32x32x16_bf16 v[80:95], v[124:127], v[252:255], v[80:95]
    s_waitcnt lgkmcnt(0)
    v_mov_b32 v24, v21
    v_mov_b32 v25, v21
    s_nop 1
    v_permlane32_swap_b32 v24, v25
    v_add_f32 v24, v24, v25
    v_rcp_f32 v24, v24
    v_mbcnt_lo_u32_b32 v28, -1, 0
    v_mbcnt_hi_u32_b32 v28, -1, v28
    v_lshrrev_b32 v30, 5, v28
    v_and_b32 v26, 15, v28
    v_xor_b32 v26, v26, v30
    v_lshlrev_b32 v26, 4, v26
    v_and_b32 v25, 31, v28
    v_lshlrev_b32 v25, 10, v25
    v_add_u32 v25, 131072, v25
    v_add_u32 v25, s49, v25
    v_xor_b32 v1, 0, v26
    v_add_u32 v1, v1, v25
    v_xor_b32 v2, 32, v26
    v_add_u32 v2, v2, v25
    v_xor_b32 v3, 64, v26
    v_add_u32 v3, v3, v25
    v_xor_b32 v4, 96, v26
    v_add_u32 v4, v4, v25
    v_xor_b32 v5, 128, v26
    v_add_u32 v5, v5, v25
    v_xor_b32 v6, 160, v26
    v_add_u32 v6, v6, v25
    v_xor_b32 v7, 192, v26
    v_add_u32 v7, v7, v25
    v_xor_b32 v8, 224, v26
    v_add_u32 v8, v8, v25
    v_mul_f32 v32, v24, v32
    v_mul_f32 v33, v24, v33
    v_cvt_pk_bf16_f32 v96, v32, v33
    v_mul_f32 v34, v24, v34
    v_mul_f32 v35, v24, v35
    v_cvt_pk_bf16_f32 v97, v34, v35
    v_mul_f32 v36, v24, v36
    v_mul_f32 v37, v24, v37
    v_cvt_pk_bf16_f32 v98, v36, v37
    v_mul_f32 v38, v24, v38
    v_mul_f32 v39, v24, v39
    v_cvt_pk_bf16_f32 v99, v38, v39
    ds_write_b128 v1, v[96:99] offset:0
    v_mul_f32 v40, v24, v40
    v_mul_f32 v41, v24, v41
    v_cvt_pk_bf16_f32 v100, v40, v41
    v_mul_f32 v42, v24, v42
    v_mul_f32 v43, v24, v43
    v_cvt_pk_bf16_f32 v101, v42, v43
    v_mul_f32 v44, v24, v44
    v_mul_f32 v45, v24, v45
    v_cvt_pk_bf16_f32 v102, v44, v45
    v_mul_f32 v46, v24, v46
    v_mul_f32 v47, v24, v47
    v_cvt_pk_bf16_f32 v103, v46, v47
    ds_write_b128 v2, v[100:103] offset:0
    v_mul_f32 v48, v24, v48
    v_mul_f32 v49, v24, v49
    v_cvt_pk_bf16_f32 v104, v48, v49
    v_mul_f32 v50, v24, v50
    v_mul_f32 v51, v24, v51
    v_cvt_pk_bf16_f32 v105, v50, v51
    v_mul_f32 v52, v24, v52
    v_mul_f32 v53, v24, v53
    v_cvt_pk_bf16_f32 v106, v52, v53
    v_mul_f32 v54, v24, v54
    v_mul_f32 v55, v24, v55
    v_cvt_pk_bf16_f32 v107, v54, v55
    ds_write_b128 v3, v[104:107] offset:0
    v_mul_f32 v56, v24, v56
    v_mul_f32 v57, v24, v57
    v_cvt_pk_bf16_f32 v108, v56, v57
    v_mul_f32 v58, v24, v58
    v_mul_f32 v59, v24, v59
    v_cvt_pk_bf16_f32 v109, v58, v59
    v_mul_f32 v60, v24, v60
    v_mul_f32 v61, v24, v61
    v_cvt_pk_bf16_f32 v110, v60, v61
    v_mul_f32 v62, v24, v62
    v_mul_f32 v63, v24, v63
    v_cvt_pk_bf16_f32 v111, v62, v63
    ds_write_b128 v4, v[108:111] offset:0
    v_mul_f32 v64, v24, v64
    v_mul_f32 v65, v24, v65
    v_cvt_pk_bf16_f32 v112, v64, v65
    v_mul_f32 v66, v24, v66
    v_mul_f32 v67, v24, v67
    v_cvt_pk_bf16_f32 v113, v66, v67
    v_mul_f32 v68, v24, v68
    v_mul_f32 v69, v24, v69
    v_cvt_pk_bf16_f32 v114, v68, v69
    v_mul_f32 v70, v24, v70
    v_mul_f32 v71, v24, v71
    v_cvt_pk_bf16_f32 v115, v70, v71
    ds_write_b128 v5, v[112:115] offset:0
    v_mul_f32 v72, v24, v72
    v_mul_f32 v73, v24, v73
    v_cvt_pk_bf16_f32 v116, v72, v73
    v_mul_f32 v74, v24, v74
    v_mul_f32 v75, v24, v75
    v_cvt_pk_bf16_f32 v117, v74, v75
    v_mul_f32 v76, v24, v76
    v_mul_f32 v77, v24, v77
    v_cvt_pk_bf16_f32 v118, v76, v77
    v_mul_f32 v78, v24, v78
    v_mul_f32 v79, v24, v79
    v_cvt_pk_bf16_f32 v119, v78, v79
    ds_write_b128 v6, v[116:119] offset:0
    v_mul_f32 v80, v24, v80
    v_mul_f32 v81, v24, v81
    v_cvt_pk_bf16_f32 v120, v80, v81
    v_mul_f32 v82, v24, v82
    v_mul_f32 v83, v24, v83
    v_cvt_pk_bf16_f32 v121, v82, v83
    v_mul_f32 v84, v24, v84
    v_mul_f32 v85, v24, v85
    v_cvt_pk_bf16_f32 v122, v84, v85
    v_mul_f32 v86, v24, v86
    v_mul_f32 v87, v24, v87
    v_cvt_pk_bf16_f32 v123, v86, v87
    ds_write_b128 v7, v[120:123] offset:0
    v_mul_f32 v88, v24, v88
    v_mul_f32 v89, v24, v89
    v_cvt_pk_bf16_f32 v124, v88, v89
    v_mul_f32 v90, v24, v90
    v_mul_f32 v91, v24, v91
    v_cvt_pk_bf16_f32 v125, v90, v91
    v_mul_f32 v92, v24, v92
    v_mul_f32 v93, v24, v93
    v_cvt_pk_bf16_f32 v126, v92, v93
    v_mul_f32 v94, v24, v94
    v_mul_f32 v95, v24, v95
    v_cvt_pk_bf16_f32 v127, v94, v95
    ds_write_b128 v8, v[124:127] offset:0
    s_waitcnt lgkmcnt(0)
    s_barrier
    ds_read_b128 v[96:99], v16 offset:256
    ds_read_b128 v[100:103], v16 offset:16640
    ds_read_b128 v[104:107], v13 offset:512
    ds_read_b128 v[108:111], v13 offset:16896
    s_waitcnt vmcnt(16)
    v_perm_b32 v224, v132, v128, s54
    v_perm_b32 v225, v140, v136, s54
    v_perm_b32 v226, v148, v144, s54
    v_perm_b32 v227, v156, v152, s54
    v_perm_b32 v228, v132, v128, s55
    v_perm_b32 v229, v140, v136, s55
    s_waitcnt lgkmcnt(2)
    v_mfma_f32_16x16x32_bf16 v[32:35], v[224:227], v[96:99], 0
    v_perm_b32 v230, v148, v144, s55
    v_perm_b32 v231, v156, v152, s55
    v_mfma_f32_16x16x32_bf16 v[36:39], v[224:227], v[100:103], 0
    v_perm_b32 v232, v133, v129, s54
    v_perm_b32 v233, v141, v137, s54
    v_mfma_f32_16x16x32_bf16 v[40:43], v[228:231], v[96:99], 0
    v_perm_b32 v234, v149, v145, s54
    v_perm_b32 v235, v157, v153, s54
    v_mfma_f32_16x16x32_bf16 v[44:47], v[228:231], v[100:103], 0
    v_perm_b32 v236, v133, v129, s55
    v_perm_b32 v237, v141, v137, s55
    v_mfma_f32_16x16x32_bf16 v[48:51], v[232:235], v[96:99], 0
    v_perm_b32 v238, v149, v145, s55
    v_perm_b32 v239, v157, v153, s55
    v_mfma_f32_16x16x32_bf16 v[52:55], v[232:235], v[100:103], 0
    v_perm_b32 v240, v134, v130, s54
    v_perm_b32 v241, v142, v138, s54
    v_mfma_f32_16x16x32_bf16 v[56:59], v[236:239], v[96:99], 0
    v_perm_b32 v242, v150, v146, s54
    v_perm_b32 v243, v158, v154, s54
    v_mfma_f32_16x16x32_bf16 v[60:63], v[236:239], v[100:103], 0
    v_perm_b32 v244, v134, v130, s55
    v_perm_b32 v245, v142, v138, s55
    v_mfma_f32_16x16x32_bf16 v[64:67], v[240:243], v[96:99], 0
    v_perm_b32 v246, v150, v146, s55
    v_perm_b32 v247, v158, v154, s55
    v_mfma_f32_16x16x32_bf16 v[68:71], v[240:243], v[100:103], 0
    v_perm_b32 v248, v135, v131, s54
    v_perm_b32 v249, v143, v139, s54
    v_mfma_f32_16x16x32_bf16 v[72:75], v[244:247], v[96:99], 0
    v_perm_b32 v250, v151, v147, s54
    v_perm_b32 v251, v159, v155, s54
    v_mfma_f32_16x16x32_bf16 v[76:79], v[244:247], v[100:103], 0
    v_perm_b32 v252, v135, v131, s55
    v_perm_b32 v253, v143, v139, s55
    v_mfma_f32_16x16x32_bf16 v[80:83], v[248:251], v[96:99], 0
    v_perm_b32 v254, v151, v147, s55
    v_perm_b32 v255, v159, v155, s55
    v_mfma_f32_16x16x32_bf16 v[84:87], v[248:251], v[100:103], 0
    s_waitcnt vmcnt(8)
    v_perm_b32 v224, v164, v160, s54
    v_perm_b32 v225, v172, v168, s54
    v_mfma_f32_16x16x32_bf16 v[88:91], v[252:255], v[96:99], 0
    v_perm_b32 v226, v180, v176, s54
    v_perm_b32 v227, v188, v184, s54
    v_mfma_f32_16x16x32_bf16 v[92:95], v[252:255], v[100:103], 0
    ds_read_b128 v[96:99], v14 offset:512
    ds_read_b128 v[100:103], v14 offset:16896
    v_perm_b32 v228, v164, v160, s55
    v_perm_b32 v229, v172, v168, s55
    s_waitcnt lgkmcnt(2)
    v_mfma_f32_16x16x32_bf16 v[32:35], v[224:227], v[104:107], v[32:35]
    s_mov_b32 s48, 327680
    buffer_load_dwordx4 v[128:131], v17, s[40:43], s48 offen offset:0
    v_perm_b32 v230, v180, v176, s55
    v_perm_b32 v231, v188, v184, s55
    v_mfma_f32_16x16x32_bf16 v[36:39], v[224:227], v[108:111], v[36:39]
    v_perm_b32 v232, v165, v161, s54
    v_perm_b32 v233, v173, v169, s54
    v_mfma_f32_16x16x32_bf16 v[40:43], v[228:231], v[104:107], v[40:43]
    buffer_load_dwordx4 v[132:135], v17, s[40:43], s48 offen offset:1024
    v_perm_b32 v234, v181, v177, s54
    v_perm_b32 v235, v189, v185, s54
    v_mfma_f32_16x16x32_bf16 v[44:47], v[228:231], v[108:111], v[44:47]
    v_perm_b32 v236, v165, v161, s55
    v_perm_b32 v237, v173, v169, s55
    v_mfma_f32_16x16x32_bf16 v[48:51], v[232:235], v[104:107], v[48:51]
    buffer_load_dwordx4 v[136:139], v17, s[40:43], s48 offen offset:2048
    v_perm_b32 v238, v181, v177, s55
    v_perm_b32 v239, v189, v185, s55
    v_mfma_f32_16x16x32_bf16 v[52:55], v[232:235], v[108:111], v[52:55]
    v_perm_b32 v240, v166, v162, s54
    v_perm_b32 v241, v174, v170, s54
    v_mfma_f32_16x16x32_bf16 v[56:59], v[236:239], v[104:107], v[56:59]
    buffer_load_dwordx4 v[140:143], v17, s[40:43], s48 offen offset:3072
    v_perm_b32 v242, v182, v178, s54
    v_perm_b32 v243, v190, v186, s54
    v_mfma_f32_16x16x32_bf16 v[60:63], v[236:239], v[108:111], v[60:63]
    v_perm_b32 v244, v166, v162, s55
    v_perm_b32 v245, v174, v170, s55
    v_mfma_f32_16x16x32_bf16 v[64:67], v[240:243], v[104:107], v[64:67]
    buffer_load_dwordx4 v[144:147], v18, s[40:43], s48 offen offset:0
    v_perm_b32 v246, v182, v178, s55
    v_perm_b32 v247, v190, v186, s55
    v_mfma_f32_16x16x32_bf16 v[68:71], v[240:243], v[108:111], v[68:71]
    v_perm_b32 v248, v167, v163, s54
    v_perm_b32 v249, v175, v171, s54
    v_mfma_f32_16x16x32_bf16 v[72:75], v[244:247], v[104:107], v[72:75]
    buffer_load_dwordx4 v[148:151], v18, s[40:43], s48 offen offset:1024
    v_perm_b32 v250, v183, v179, s54
    v_perm_b32 v251, v191, v187, s54
    v_mfma_f32_16x16x32_bf16 v[76:79], v[244:247], v[108:111], v[76:79]
    v_perm_b32 v252, v167, v163, s55
    v_perm_b32 v253, v175, v171, s55
    v_mfma_f32_16x16x32_bf16 v[80:83], v[248:251], v[104:107], v[80:83]
    buffer_load_dwordx4 v[152:155], v18, s[40:43], s48 offen offset:2048
    v_perm_b32 v254, v183, v179, s55
    v_perm_b32 v255, v191, v187, s55
    v_mfma_f32_16x16x32_bf16 v[84:87], v[248:251], v[108:111], v[84:87]
    s_waitcnt vmcnt(7)
    v_perm_b32 v224, v196, v192, s54
    v_perm_b32 v225, v204, v200, s54
    v_mfma_f32_16x16x32_bf16 v[88:91], v[252:255], v[104:107], v[88:91]
    buffer_load_dwordx4 v[156:159], v18, s[40:43], s48 offen offset:3072
    v_perm_b32 v226, v212, v208, s54
    v_perm_b32 v227, v220, v216, s54
    v_mfma_f32_16x16x32_bf16 v[92:95], v[252:255], v[108:111], v[92:95]
    ds_read_b128 v[104:107], v15 offset:512
    ds_read_b128 v[108:111], v15 offset:16896
    v_perm_b32 v228, v196, v192, s55
    v_perm_b32 v229, v204, v200, s55
    s_waitcnt lgkmcnt(2)
    v_mfma_f32_16x16x32_bf16 v[32:35], v[224:227], v[96:99], v[32:35]
    s_mov_b32 s48, 360448
    buffer_load_dwordx4 v[160:163], v17, s[40:43], s48 offen offset:0
    v_perm_b32 v230, v212, v208, s55
    v_perm_b32 v231, v220, v216, s55
    v_mfma_f32_16x16x32_bf16 v[36:39], v[224:227], v[100:103], v[36:39]
    v_perm_b32 v232, v197, v193, s54
    v_perm_b32 v233, v205, v201, s54
    v_mfma_f32_16x16x32_bf16 v[40:43], v[228:231], v[96:99], v[40:43]
    buffer_load_dwordx4 v[164:167], v17, s[40:43], s48 offen offset:1024
    v_perm_b32 v234, v213, v209, s54
    v_perm_b32 v235, v221, v217, s54
    v_mfma_f32_16x16x32_bf16 v[44:47], v[228:231], v[100:103], v[44:47]
    v_perm_b32 v236, v197, v193, s55
    v_perm_b32 v237, v205, v201, s55
    v_mfma_f32_16x16x32_bf16 v[48:51], v[232:235], v[96:99], v[48:51]
    buffer_load_dwordx4 v[168:171], v17, s[40:43], s48 offen offset:2048
    v_perm_b32 v238, v213, v209, s55
    v_perm_b32 v239, v221, v217, s55
    v_mfma_f32_16x16x32_bf16 v[52:55], v[232:235], v[100:103], v[52:55]
    v_perm_b32 v240, v198, v194, s54
    v_perm_b32 v241, v206, v202, s54
    v_mfma_f32_16x16x32_bf16 v[56:59], v[236:239], v[96:99], v[56:59]
    buffer_load_dwordx4 v[172:175], v17, s[40:43], s48 offen offset:3072
    v_perm_b32 v242, v214, v210, s54
    v_perm_b32 v243, v222, v218, s54
    v_mfma_f32_16x16x32_bf16 v[60:63], v[236:239], v[100:103], v[60:63]
    v_perm_b32 v244, v198, v194, s55
    v_perm_b32 v245, v206, v202, s55
    v_mfma_f32_16x16x32_bf16 v[64:67], v[240:243], v[96:99], v[64:67]
    buffer_load_dwordx4 v[176:179], v18, s[40:43], s48 offen offset:0
    v_perm_b32 v246, v214, v210, s55
    v_perm_b32 v247, v222, v218, s55
    v_mfma_f32_16x16x32_bf16 v[68:71], v[240:243], v[100:103], v[68:71]
    v_perm_b32 v248, v199, v195, s54
    v_perm_b32 v249, v207, v203, s54
    v_mfma_f32_16x16x32_bf16 v[72:75], v[244:247], v[96:99], v[72:75]
    buffer_load_dwordx4 v[180:183], v18, s[40:43], s48 offen offset:1024
    v_perm_b32 v250, v215, v211, s54
    v_perm_b32 v251, v223, v219, s54
    v_mfma_f32_16x16x32_bf16 v[76:79], v[244:247], v[100:103], v[76:79]
    v_perm_b32 v252, v199, v195, s55
    v_perm_b32 v253, v207, v203, s55
    v_mfma_f32_16x16x32_bf16 v[80:83], v[248:251], v[96:99], v[80:83]
    buffer_load_dwordx4 v[184:187], v18, s[40:43], s48 offen offset:2048
    v_perm_b32 v254, v215, v211, s55
    v_perm_b32 v255, v223, v219, s55
    v_mfma_f32_16x16x32_bf16 v[84:87], v[248:251], v[100:103], v[84:87]
    s_waitcnt vmcnt(7)
    v_perm_b32 v224, v132, v128, s54
    v_perm_b32 v225, v140, v136, s54
    v_mfma_f32_16x16x32_bf16 v[88:91], v[252:255], v[96:99], v[88:91]
    buffer_load_dwordx4 v[188:191], v18, s[40:43], s48 offen offset:3072
    v_perm_b32 v226, v148, v144, s54
    v_perm_b32 v227, v156, v152, s54
    v_mfma_f32_16x16x32_bf16 v[92:95], v[252:255], v[100:103], v[92:95]
    ds_read_b128 v[96:99], v16 offset:512
    ds_read_b128 v[100:103], v16 offset:16896
    v_perm_b32 v228, v132, v128, s55
    v_perm_b32 v229, v140, v136, s55
    s_waitcnt lgkmcnt(2)
    v_mfma_f32_16x16x32_bf16 v[32:35], v[224:227], v[104:107], v[32:35]
    s_mov_b32 s48, 393216
    buffer_load_dwordx4 v[192:195], v17, s[40:43], s48 offen offset:0
    v_perm_b32 v230, v148, v144, s55
    v_perm_b32 v231, v156, v152, s55
    v_mfma_f32_16x16x32_bf16 v[36:39], v[224:227], v[108:111], v[36:39]
    v_perm_b32 v232, v133, v129, s54
    v_perm_b32 v233, v141, v137, s54
    v_mfma_f32_16x16x32_bf16 v[40:43], v[228:231], v[104:107], v[40:43]
    buffer_load_dwordx4 v[196:199], v17, s[40:43], s48 offen offset:1024
    v_perm_b32 v234, v149, v145, s54
    v_perm_b32 v235, v157, v153, s54
    v_mfma_f32_16x16x32_bf16 v[44:47], v[228:231], v[108:111], v[44:47]
    v_perm_b32 v236, v133, v129, s55
    v_perm_b32 v237, v141, v137, s55
    v_mfma_f32_16x16x32_bf16 v[48:51], v[232:235], v[104:107], v[48:51]
    buffer_load_dwordx4 v[200:203], v17, s[40:43], s48 offen offset:2048
    v_perm_b32 v238, v149, v145, s55
    v_perm_b32 v239, v157, v153, s55
    v_mfma_f32_16x16x32_bf16 v[52:55], v[232:235], v[108:111], v[52:55]
    v_perm_b32 v240, v134, v130, s54
    v_perm_b32 v241, v142, v138, s54
    v_mfma_f32_16x16x32_bf16 v[56:59], v[236:239], v[104:107], v[56:59]
    buffer_load_dwordx4 v[204:207], v17, s[40:43], s48 offen offset:3072
    v_perm_b32 v242, v150, v146, s54
    v_perm_b32 v243, v158, v154, s54
    v_mfma_f32_16x16x32_bf16 v[60:63], v[236:239], v[108:111], v[60:63]
    v_perm_b32 v244, v134, v130, s55
    v_perm_b32 v245, v142, v138, s55
    v_mfma_f32_16x16x32_bf16 v[64:67], v[240:243], v[104:107], v[64:67]
    buffer_load_dwordx4 v[208:211], v18, s[40:43], s48 offen offset:0
    v_perm_b32 v246, v150, v146, s55
    v_perm_b32 v247, v158, v154, s55
    v_mfma_f32_16x16x32_bf16 v[68:71], v[240:243], v[108:111], v[68:71]
    v_perm_b32 v248, v135, v131, s54
    v_perm_b32 v249, v143, v139, s54
    v_mfma_f32_16x16x32_bf16 v[72:75], v[244:247], v[104:107], v[72:75]
    buffer_load_dwordx4 v[212:215], v18, s[40:43], s48 offen offset:1024
    v_perm_b32 v250, v151, v147, s54
    v_perm_b32 v251, v159, v155, s54
    v_mfma_f32_16x16x32_bf16 v[76:79], v[244:247], v[108:111], v[76:79]
    v_perm_b32 v252, v135, v131, s55
    v_perm_b32 v253, v143, v139, s55
    v_mfma_f32_16x16x32_bf16 v[80:83], v[248:251], v[104:107], v[80:83]
    buffer_load_dwordx4 v[216:219], v18, s[40:43], s48 offen offset:2048
    v_perm_b32 v254, v151, v147, s55
    v_perm_b32 v255, v159, v155, s55
    v_mfma_f32_16x16x32_bf16 v[84:87], v[248:251], v[108:111], v[84:87]
    s_waitcnt vmcnt(7)
    v_perm_b32 v224, v164, v160, s54
    v_perm_b32 v225, v172, v168, s54
    v_mfma_f32_16x16x32_bf16 v[88:91], v[252:255], v[104:107], v[88:91]
    buffer_load_dwordx4 v[220:223], v18, s[40:43], s48 offen offset:3072
    v_perm_b32 v226, v180, v176, s54
    v_perm_b32 v227, v188, v184, s54
    v_mfma_f32_16x16x32_bf16 v[92:95], v[252:255], v[108:111], v[92:95]
    ds_read_b128 v[104:107], v13 offset:768
    ds_read_b128 v[108:111], v13 offset:17152
    v_perm_b32 v228, v164, v160, s55
    v_perm_b32 v229, v172, v168, s55
    s_waitcnt lgkmcnt(2)
    v_mfma_f32_16x16x32_bf16 v[32:35], v[224:227], v[96:99], v[32:35]
    s_mov_b32 s48, 425984
    buffer_load_dwordx4 v[128:131], v17, s[40:43], s48 offen offset:0
    v_perm_b32 v230, v180, v176, s55
    v_perm_b32 v231, v188, v184, s55
    v_mfma_f32_16x16x32_bf16 v[36:39], v[224:227], v[100:103], v[36:39]
    v_perm_b32 v232, v165, v161, s54
    v_perm_b32 v233, v173, v169, s54
    v_mfma_f32_16x16x32_bf16 v[40:43], v[228:231], v[96:99], v[40:43]
    buffer_load_dwordx4 v[132:135], v17, s[40:43], s48 offen offset:1024
    v_perm_b32 v234, v181, v177, s54
    v_perm_b32 v235, v189, v185, s54
    v_mfma_f32_16x16x32_bf16 v[44:47], v[228:231], v[100:103], v[44:47]
    v_perm_b32 v236, v165, v161, s55
    v_perm_b32 v237, v173, v169, s55
    v_mfma_f32_16x16x32_bf16 v[48:51], v[232:235], v[96:99], v[48:51]
    buffer_load_dwordx4 v[136:139], v17, s[40:43], s48 offen offset:2048
    v_perm_b32 v238, v181, v177, s55
    v_perm_b32 v239, v189, v185, s55
    v_mfma_f32_16x16x32_bf16 v[52:55], v[232:235], v[100:103], v[52:55]
    v_perm_b32 v240, v166, v162, s54
    v_perm_b32 v241, v174, v170, s54
    v_mfma_f32_16x16x32_bf16 v[56:59], v[236:239], v[96:99], v[56:59]
    buffer_load_dwordx4 v[140:143], v17, s[40:43], s48 offen offset:3072
    v_perm_b32 v242, v182, v178, s54
    v_perm_b32 v243, v190, v186, s54
    v_mfma_f32_16x16x32_bf16 v[60:63], v[236:239], v[100:103], v[60:63]
    v_perm_b32 v244, v166, v162, s55
    v_perm_b32 v245, v174, v170, s55
    v_mfma_f32_16x16x32_bf16 v[64:67], v[240:243], v[96:99], v[64:67]
    buffer_load_dwordx4 v[144:147], v18, s[40:43], s48 offen offset:0
    v_perm_b32 v246, v182, v178, s55
    v_perm_b32 v247, v190, v186, s55
    v_mfma_f32_16x16x32_bf16 v[68:71], v[240:243], v[100:103], v[68:71]
    v_perm_b32 v248, v167, v163, s54
    v_perm_b32 v249, v175, v171, s54
    v_mfma_f32_16x16x32_bf16 v[72:75], v[244:247], v[96:99], v[72:75]
    buffer_load_dwordx4 v[148:151], v18, s[40:43], s48 offen offset:1024
    v_perm_b32 v250, v183, v179, s54
    v_perm_b32 v251, v191, v187, s54
    v_mfma_f32_16x16x32_bf16 v[76:79], v[244:247], v[100:103], v[76:79]
    v_perm_b32 v252, v167, v163, s55
    v_perm_b32 v253, v175, v171, s55
    v_mfma_f32_16x16x32_bf16 v[80:83], v[248:251], v[96:99], v[80:83]
    buffer_load_dwordx4 v[152:155], v18, s[40:43], s48 offen offset:2048
    v_perm_b32 v254, v183, v179, s55
    v_perm_b32 v255, v191, v187, s55
    v_mfma_f32_16x16x32_bf16 v[84:87], v[248:251], v[100:103], v[84:87]
    s_waitcnt vmcnt(7)
    v_perm_b32 v224, v196, v192, s54
    v_perm_b32 v225, v204, v200, s54
    v_mfma_f32_16x16x32_bf16 v[88:91], v[252:255], v[96:99], v[88:91]
    buffer_load_dwordx4 v[156:159], v18, s[40:43], s48 offen offset:3072
    v_perm_b32 v226, v212, v208, s54
    v_perm_b32 v227, v220, v216, s54
    v_mfma_f32_16x16x32_bf16 v[92:95], v[252:255], v[100:103], v[92:95]
    ds_read_b128 v[96:99], v14 offset:768
    ds_read_b128 v[100:103], v14 offset:17152
    v_perm_b32 v228, v196, v192, s55
    v_perm_b32 v229, v204, v200, s55
    s_waitcnt lgkmcnt(2)
    v_mfma_f32_16x16x32_bf16 v[32:35], v[224:227], v[104:107], v[32:35]
    s_mov_b32 s48, 458752
    buffer_load_dwordx4 v[160:163], v17, s[40:43], s48 offen offset:0
    v_perm_b32 v230, v212, v208, s55
    v_perm_b32 v231, v220, v216, s55
    v_mfma_f32_16x16x32_bf16 v[36:39], v[224:227], v[108:111], v[36:39]
    v_perm_b32 v232, v197, v193, s54
    v_perm_b32 v233, v205, v201, s54
    v_mfma_f32_16x16x32_bf16 v[40:43], v[228:231], v[104:107], v[40:43]
    buffer_load_dwordx4 v[164:167], v17, s[40:43], s48 offen offset:1024
    v_perm_b32 v234, v213, v209, s54
    v_perm_b32 v235, v221, v217, s54
    v_mfma_f32_16x16x32_bf16 v[44:47], v[228:231], v[108:111], v[44:47]
    v_perm_b32 v236, v197, v193, s55
    v_perm_b32 v237, v205, v201, s55
    v_mfma_f32_16x16x32_bf16 v[48:51], v[232:235], v[104:107], v[48:51]
    buffer_load_dwordx4 v[168:171], v17, s[40:43], s48 offen offset:2048
    v_perm_b32 v238, v213, v209, s55
    v_perm_b32 v239, v221, v217, s55
    v_mfma_f32_16x16x32_bf16 v[52:55], v[232:235], v[108:111], v[52:55]
    v_perm_b32 v240, v198, v194, s54
    v_perm_b32 v241, v206, v202, s54
    v_mfma_f32_16x16x32_bf16 v[56:59], v[236:239], v[104:107], v[56:59]
    buffer_load_dwordx4 v[172:175], v17, s[40:43], s48 offen offset:3072
    v_perm_b32 v242, v214, v210, s54
    v_perm_b32 v243, v222, v218, s54
    v_mfma_f32_16x16x32_bf16 v[60:63], v[236:239], v[108:111], v[60:63]
    v_perm_b32 v244, v198, v194, s55
    v_perm_b32 v245, v206, v202, s55
    v_mfma_f32_16x16x32_bf16 v[64:67], v[240:243], v[104:107], v[64:67]
    buffer_load_dwordx4 v[176:179], v18, s[40:43], s48 offen offset:0
    v_perm_b32 v246, v214, v210, s55
    v_perm_b32 v247, v222, v218, s55
    v_mfma_f32_16x16x32_bf16 v[68:71], v[240:243], v[108:111], v[68:71]
    v_perm_b32 v248, v199, v195, s54
    v_perm_b32 v249, v207, v203, s54
    v_mfma_f32_16x16x32_bf16 v[72:75], v[244:247], v[104:107], v[72:75]
    buffer_load_dwordx4 v[180:183], v18, s[40:43], s48 offen offset:1024
    v_perm_b32 v250, v215, v211, s54
    v_perm_b32 v251, v223, v219, s54
    v_mfma_f32_16x16x32_bf16 v[76:79], v[244:247], v[108:111], v[76:79]
    v_perm_b32 v252, v199, v195, s55
    v_perm_b32 v253, v207, v203, s55
    v_mfma_f32_16x16x32_bf16 v[80:83], v[248:251], v[104:107], v[80:83]
    buffer_load_dwordx4 v[184:187], v18, s[40:43], s48 offen offset:2048
    v_perm_b32 v254, v215, v211, s55
    v_perm_b32 v255, v223, v219, s55
    v_mfma_f32_16x16x32_bf16 v[84:87], v[248:251], v[108:111], v[84:87]
    s_waitcnt vmcnt(7)
    v_perm_b32 v224, v132, v128, s54
    v_perm_b32 v225, v140, v136, s54
    v_mfma_f32_16x16x32_bf16 v[88:91], v[252:255], v[104:107], v[88:91]
    buffer_load_dwordx4 v[188:191], v18, s[40:43], s48 offen offset:3072
    v_perm_b32 v226, v148, v144, s54
    v_perm_b32 v227, v156, v152, s54
    v_mfma_f32_16x16x32_bf16 v[92:95], v[252:255], v[108:111], v[92:95]
    ds_read_b128 v[104:107], v15 offset:768
    ds_read_b128 v[108:111], v15 offset:17152
    v_perm_b32 v228, v132, v128, s55
    v_perm_b32 v229, v140, v136, s55
    s_waitcnt lgkmcnt(2)
    v_mfma_f32_16x16x32_bf16 v[32:35], v[224:227], v[96:99], v[32:35]
    s_mov_b32 s48, 491520
    buffer_load_dwordx4 v[192:195], v17, s[40:43], s48 offen offset:0
    v_perm_b32 v230, v148, v144, s55
    v_perm_b32 v231, v156, v152, s55
    v_mfma_f32_16x16x32_bf16 v[36:39], v[224:227], v[100:103], v[36:39]
    v_perm_b32 v232, v133, v129, s54
    v_perm_b32 v233, v141, v137, s54
    v_mfma_f32_16x16x32_bf16 v[40:43], v[228:231], v[96:99], v[40:43]
    buffer_load_dwordx4 v[196:199], v17, s[40:43], s48 offen offset:1024
    v_perm_b32 v234, v149, v145, s54
    v_perm_b32 v235, v157, v153, s54
    v_mfma_f32_16x16x32_bf16 v[44:47], v[228:231], v[100:103], v[44:47]
    v_perm_b32 v236, v133, v129, s55
    v_perm_b32 v237, v141, v137, s55
    v_mfma_f32_16x16x32_bf16 v[48:51], v[232:235], v[96:99], v[48:51]
    buffer_load_dwordx4 v[200:203], v17, s[40:43], s48 offen offset:2048
    v_perm_b32 v238, v149, v145, s55
    v_perm_b32 v239, v157, v153, s55
    v_mfma_f32_16x16x32_bf16 v[52:55], v[232:235], v[100:103], v[52:55]
    v_perm_b32 v240, v134, v130, s54
    v_perm_b32 v241, v142, v138, s54
    v_mfma_f32_16x16x32_bf16 v[56:59], v[236:239], v[96:99], v[56:59]
    buffer_load_dwordx4 v[204:207], v17, s[40:43], s48 offen offset:3072
    v_perm_b32 v242, v150, v146, s54
    v_perm_b32 v243, v158, v154, s54
    v_mfma_f32_16x16x32_bf16 v[60:63], v[236:239], v[100:103], v[60:63]
    v_perm_b32 v244, v134, v130, s55
    v_perm_b32 v245, v142, v138, s55
    v_mfma_f32_16x16x32_bf16 v[64:67], v[240:243], v[96:99], v[64:67]
    buffer_load_dwordx4 v[208:211], v18, s[40:43], s48 offen offset:0
    v_perm_b32 v246, v150, v146, s55
    v_perm_b32 v247, v158, v154, s55
    v_mfma_f32_16x16x32_bf16 v[68:71], v[240:243], v[100:103], v[68:71]
    v_perm_b32 v248, v135, v131, s54
    v_perm_b32 v249, v143, v139, s54
    v_mfma_f32_16x16x32_bf16 v[72:75], v[244:247], v[96:99], v[72:75]
    buffer_load_dwordx4 v[212:215], v18, s[40:43], s48 offen offset:1024
    v_perm_b32 v250, v151, v147, s54
    v_perm_b32 v251, v159, v155, s54
    v_mfma_f32_16x16x32_bf16 v[76:79], v[244:247], v[100:103], v[76:79]
    v_perm_b32 v252, v135, v131, s55
    v_perm_b32 v253, v143, v139, s55
    v_mfma_f32_16x16x32_bf16 v[80:83], v[248:251], v[96:99], v[80:83]
    buffer_load_dwordx4 v[216:219], v18, s[40:43], s48 offen offset:2048
    v_perm_b32 v254, v151, v147, s55
    v_perm_b32 v255, v159, v155, s55
    v_mfma_f32_16x16x32_bf16 v[84:87], v[248:251], v[100:103], v[84:87]
    s_waitcnt vmcnt(7)
    v_perm_b32 v224, v164, v160, s54
    v_perm_b32 v225, v172, v168, s54
    v_mfma_f32_16x16x32_bf16 v[88:91], v[252:255], v[96:99], v[88:91]
    buffer_load_dwordx4 v[220:223], v18, s[40:43], s48 offen offset:3072
    v_perm_b32 v226, v180, v176, s54
    v_perm_b32 v227, v188, v184, s54
    v_mfma_f32_16x16x32_bf16 v[92:95], v[252:255], v[100:103], v[92:95]
    ds_read_b128 v[96:99], v16 offset:768
    ds_read_b128 v[100:103], v16 offset:17152
    v_perm_b32 v228, v164, v160, s55
    v_perm_b32 v229, v172, v168, s55
    s_waitcnt lgkmcnt(2)
    v_mfma_f32_16x16x32_bf16 v[32:35], v[224:227], v[104:107], v[32:35]
    v_perm_b32 v230, v180, v176, s55
    v_perm_b32 v231, v188, v184, s55
    v_mfma_f32_16x16x32_bf16 v[36:39], v[224:227], v[108:111], v[36:39]
    v_perm_b32 v232, v165, v161, s54
    v_perm_b32 v233, v173, v169, s54
    v_mfma_f32_16x16x32_bf16 v[40:43], v[228:231], v[104:107], v[40:43]
    v_perm_b32 v234, v181, v177, s54
    v_perm_b32 v235, v189, v185, s54
    v_mfma_f32_16x16x32_bf16 v[44:47], v[228:231], v[108:111], v[44:47]
    v_perm_b32 v236, v165, v161, s55
    v_perm_b32 v237, v173, v169, s55
    v_mfma_f32_16x16x32_bf16 v[48:51], v[232:235], v[104:107], v[48:51]
    v_perm_b32 v238, v181, v177, s55
    v_perm_b32 v239, v189, v185, s55
    v_mfma_f32_16x16x32_bf16 v[52:55], v[232:235], v[108:111], v[52:55]
    v_perm_b32 v240, v166, v162, s54
    v_perm_b32 v241, v174, v170, s54
    v_mfma_f32_16x16x32_bf16 v[56:59], v[236:239], v[104:107], v[56:59]
    v_perm_b32 v242, v182, v178, s54
    v_perm_b32 v243, v190, v186, s54
    v_mfma_f32_16x16x32_bf16 v[60:63], v[236:239], v[108:111], v[60:63]
    v_perm_b32 v244, v166, v162, s55
    v_perm_b32 v245, v174, v170, s55
    v_mfma_f32_16x16x32_bf16 v[64:67], v[240:243], v[104:107], v[64:67]
    v_perm_b32 v246, v182, v178, s55
    v_perm_b32 v247, v190, v186, s55
    v_mfma_f32_16x16x32_bf16 v[68:71], v[240:243], v[108:111], v[68:71]
    v_perm_b32 v248, v167, v163, s54
    v_perm_b32 v249, v175, v171, s54
    v_mfma_f32_16x16x32_bf16 v[72:75], v[244:247], v[104:107], v[72:75]
    v_perm_b32 v250, v183, v179, s54
    v_perm_b32 v251, v191, v187, s54
    v_mfma_f32_16x16x32_bf16 v[76:79], v[244:247], v[108:111], v[76:79]
    v_perm_b32 v252, v167, v163, s55
    v_perm_b32 v253, v175, v171, s55
    v_mfma_f32_16x16x32_bf16 v[80:83], v[248:251], v[104:107], v[80:83]
    v_perm_b32 v254, v183, v179, s55
    v_perm_b32 v255, v191, v187, s55
    v_mfma_f32_16x16x32_bf16 v[84:87], v[248:251], v[108:111], v[84:87]
    s_waitcnt vmcnt(0)
    v_perm_b32 v224, v196, v192, s54
    v_perm_b32 v225, v204, v200, s54
    v_mfma_f32_16x16x32_bf16 v[88:91], v[252:255], v[104:107], v[88:91]
    v_perm_b32 v226, v212, v208, s54
    v_perm_b32 v227, v220, v216, s54
    v_mfma_f32_16x16x32_bf16 v[92:95], v[252:255], v[108:111], v[92:95]
    v_perm_b32 v228, v196, v192, s55
    v_perm_b32 v229, v204, v200, s55
    s_waitcnt lgkmcnt(0)
    v_mfma_f32_16x16x32_bf16 v[32:35], v[224:227], v[96:99], v[32:35]
    v_perm_b32 v230, v212, v208, s55
    v_perm_b32 v231, v220, v216, s55
    v_mfma_f32_16x16x32_bf16 v[36:39], v[224:227], v[100:103], v[36:39]
    v_perm_b32 v232, v197, v193, s54
    v_perm_b32 v233, v205, v201, s54
    v_mfma_f32_16x16x32_bf16 v[40:43], v[228:231], v[96:99], v[40:43]
    v_perm_b32 v234, v213, v209, s54
    v_perm_b32 v235, v221, v217, s54
    v_mfma_f32_16x16x32_bf16 v[44:47], v[228:231], v[100:103], v[44:47]
    v_perm_b32 v236, v197, v193, s55
    v_perm_b32 v237, v205, v201, s55
    v_mfma_f32_16x16x32_bf16 v[48:51], v[232:235], v[96:99], v[48:51]
    v_perm_b32 v238, v213, v209, s55
    v_perm_b32 v239, v221, v217, s55
    v_mfma_f32_16x16x32_bf16 v[52:55], v[232:235], v[100:103], v[52:55]
    v_perm_b32 v240, v198, v194, s54
    v_perm_b32 v241, v206, v202, s54
    v_mfma_f32_16x16x32_bf16 v[56:59], v[236:239], v[96:99], v[56:59]
    v_perm_b32 v242, v214, v210, s54
    v_perm_b32 v243, v222, v218, s54
    v_mfma_f32_16x16x32_bf16 v[60:63], v[236:239], v[100:103], v[60:63]
    v_perm_b32 v244, v198, v194, s55
    v_perm_b32 v245, v206, v202, s55
    v_mfma_f32_16x16x32_bf16 v[64:67], v[240:243], v[96:99], v[64:67]
    v_perm_b32 v246, v214, v210, s55
    v_perm_b32 v247, v222, v218, s55
    v_mfma_f32_16x16x32_bf16 v[68:71], v[240:243], v[100:103], v[68:71]
    v_perm_b32 v248, v199, v195, s54
    v_perm_b32 v249, v207, v203, s54
    v_mfma_f32_16x16x32_bf16 v[72:75], v[244:247], v[96:99], v[72:75]
    v_perm_b32 v250, v215, v211, s54
    v_perm_b32 v251, v223, v219, s54
    v_mfma_f32_16x16x32_bf16 v[76:79], v[244:247], v[100:103], v[76:79]
    v_perm_b32 v252, v199, v195, s55
    v_perm_b32 v253, v207, v203, s55
    v_mfma_f32_16x16x32_bf16 v[80:83], v[248:251], v[96:99], v[80:83]
    v_perm_b32 v254, v215, v211, s55
    v_perm_b32 v255, v223, v219, s55
    v_mfma_f32_16x16x32_bf16 v[84:87], v[248:251], v[100:103], v[84:87]
    s_nop 0
    v_mfma_f32_16x16x32_bf16 v[88:91], v[252:255], v[96:99], v[88:91]
    v_mfma_f32_16x16x32_bf16 v[92:95], v[252:255], v[100:103], v[92:95]
    v_lshlrev_b32 v24, 4, v28
    s_lshl_b32 s51, s22, 13
    v_add_u32 v1, s51, v24
    s_xor_b32 s51, s51, 32768
    v_add_u32 v2, s51, v24
    ds_write_b128 v1, v[36:39] offset:0
    ds_write_b128 v1, v[44:47] offset:1024
    ds_write_b128 v1, v[52:55] offset:2048
    ds_write_b128 v1, v[60:63] offset:3072
    ds_write_b128 v1, v[68:71] offset:4096
    ds_write_b128 v1, v[76:79] offset:5120
    ds_write_b128 v1, v[84:87] offset:6144
    ds_write_b128 v1, v[92:95] offset:7168
    s_lshl_b32 s51, s22, 12
    s_nop 0
    v_add_u32 v1, s51, v24
    s_lshl_b32 s52, s21, 15
    s_waitcnt lgkmcnt(0)
    s_barrier
    ds_read_b128 v[128:131], v2 offset:0
    ds_read_b128 v[132:135], v2 offset:1024
    ds_read_b128 v[136:139], v2 offset:2048
    ds_read_b128 v[140:143], v2 offset:3072
    ds_read_b128 v[144:147], v2 offset:4096
    ds_read_b128 v[148:151], v2 offset:5120
    ds_read_b128 v[152:155], v2 offset:6144
    ds_read_b128 v[156:159], v2 offset:7168
    s_waitcnt lgkmcnt(7)
    v_add_f32 v32, v32, v128
    v_add_f32 v33, v33, v129
    v_add_f32 v34, v34, v130
    v_add_f32 v35, v35, v131
    s_waitcnt lgkmcnt(6)
    v_add_f32 v40, v40, v132
    v_add_f32 v41, v41, v133
    v_add_f32 v42, v42, v134
    v_add_f32 v43, v43, v135
    s_waitcnt lgkmcnt(5)
    v_add_f32 v48, v48, v136
    v_add_f32 v49, v49, v137
    v_add_f32 v50, v50, v138
    v_add_f32 v51, v51, v139
    s_waitcnt lgkmcnt(4)
    v_add_f32 v56, v56, v140
    v_add_f32 v57, v57, v141
    v_add_f32 v58, v58, v142
    v_add_f32 v59, v59, v143
    s_waitcnt lgkmcnt(3)
    v_add_f32 v64, v64, v144
    v_add_f32 v65, v65, v145
    v_add_f32 v66, v66, v146
    v_add_f32 v67, v67, v147
    s_waitcnt lgkmcnt(2)
    v_add_f32 v72, v72, v148
    v_add_f32 v73, v73, v149
    v_add_f32 v74, v74, v150
    v_add_f32 v75, v75, v151
    s_waitcnt lgkmcnt(1)
    v_add_f32 v80, v80, v152
    v_add_f32 v81, v81, v153
    v_add_f32 v82, v82, v154
    v_add_f32 v83, v83, v155
    s_waitcnt lgkmcnt(0)
    v_add_f32 v88, v88, v156
    v_add_f32 v89, v89, v157
    v_add_f32 v90, v90, v158
    v_add_f32 v91, v91, v159
    v_cvt_pk_bf16_f32 v160, v32, v40
    v_cvt_pk_bf16_f32 v161, v48, v56
    v_cvt_pk_bf16_f32 v162, v64, v72
    v_cvt_pk_bf16_f32 v163, v80, v88
    buffer_store_dwordx4 v[160:163], v1, s[44:47], s52 offen offset:0
    v_cvt_pk_bf16_f32 v164, v33, v41
    v_cvt_pk_bf16_f32 v165, v49, v57
    v_cvt_pk_bf16_f32 v166, v65, v73
    v_cvt_pk_bf16_f32 v167, v81, v89
    buffer_store_dwordx4 v[164:167], v1, s[44:47], s52 offen offset:1024
    v_cvt_pk_bf16_f32 v168, v34, v42
    v_cvt_pk_bf16_f32 v169, v50, v58
    v_cvt_pk_bf16_f32 v170, v66, v74
    v_cvt_pk_bf16_f32 v171, v82, v90
    buffer_store_dwordx4 v[168:171], v1, s[44:47], s52 offen offset:2048
    v_cvt_pk_bf16_f32 v172, v35, v43
    v_cvt_pk_bf16_f32 v173, v51, v59
    v_cvt_pk_bf16_f32 v174, v67, v75
    v_cvt_pk_bf16_f32 v175, v83, v91
    buffer_store_dwordx4 v[172:175], v1, s[44:47], s52 offen offset:3072
    s_endpgm
L_kvload:
    v_and_b32 v9, 63, v0
    v_lshrrev_b32 v11, 4, v9
    v_and_b32 v12, 15, v9
    v_lshlrev_b32 v13, 8, v11
    v_add_u32 v14, 0, v11
    v_xor_b32 v14, v14, v12
    v_lshlrev_b32 v14, 4, v14
    v_add_u32 v1, v14, v13
    v_add_u32 v14, 4, v11
    v_xor_b32 v14, v14, v12
    v_lshlrev_b32 v14, 4, v14
    v_add_u32 v2, v14, v13
    v_add_u32 v14, 8, v11
    v_xor_b32 v14, v14, v12
    v_lshlrev_b32 v14, 4, v14
    v_add_u32 v3, v14, v13
    v_add_u32 v14, 12, v11
    v_xor_b32 v14, v14, v12
    v_lshlrev_b32 v14, 4, v14
    v_add_u32 v4, v14, v13
    v_lshlrev_b32 v14, 2, v11
    v_xor_b32 v14, v14, v12
    v_lshlrev_b32 v14, 4, v14
    v_add_u32 v5, v14, v13
    s_add_u32 s58, s20, s21
    s_and_b32 s51, s22, 3
    s_lshl_b32 s49, s51, 12
    v_and_b32 v8, 63, v0
    v_lshlrev_b32 v9, 4, v8
    v_add_u32 v9, s49, v9
    v_add_u32 v10, 65536, v9
    s_add_u32 s28, s28, s49
    s_addc_u32 s29, s29, 0
    s_sub_u32 s30, s30, s49
    s_add_u32 s32, s32, s49
    s_addc_u32 s33, s33, 0
    s_sub_u32 s34, s34, s49
    v_lshlrev_b32 v14, 4, v8
    s_lshl_b32 s52, s20, 4
    s_lshl_b32 s53, s51, 2
    s_add_u32 s52, s52, s53
    s_lshl_b32 s53, s52, 13
    s_lshl_b32 s48, s21, 10
    s_add_u32 s53, s53, s48
    buffer_load_dwordx4 v[16:19], v14, s[36:39], s53 offen offset:0
    s_add_u32 s53, s53, 8192
    buffer_load_dwordx4 v[20:23], v14, s[36:39], s53 offen offset:0
    s_add_u32 s53, s53, 8192
    buffer_load_dwordx4 v[24:27], v14, s[36:39], s53 offen offset:0
    s_add_u32 s53, s53, 8192
    buffer_load_dwordx4 v[28:31], v14, s[36:39], s53 offen offset:0
    s_add_u32 s53, s53, 8192
    s_lshl_b32 s53, s21, 19
    s_lshl_b32 s52, s52, 10
    s_add_u32 s53, s53, s52
    buffer_load_dwordx4 v[32:35], v14, s[40:43], s53 offen offset:0
    buffer_load_dwordx4 v[36:39], v14, s[40:43], s53 offen offset:1024
    buffer_load_dwordx4 v[40:43], v14, s[40:43], s53 offen offset:2048
    buffer_load_dwordx4 v[44:47], v14, s[40:43], s53 offen offset:3072
    s_lshl_b32 s52, s21, 19
    s_lshl_b32 s53, s51, 8
    s_add_u32 s52, s52, s53
    s_add_u32 s40, s40, s52
    s_addc_u32 s41, s41, 0
    s_sub_u32 s42, s42, s52
    v_and_b32 v14, 15, v8
    v_lshlrev_b32 v14, 4, v14
    v_lshrrev_b32 v15, 4, v8
    v_lshlrev_b32 v15, 13, v15
    v_add_u32 v6, v14, v15
    v_add_u32 v7, 4096, v6
    v_and_b32 v11, 15, v8
    v_lshrrev_b32 v15, 4, v8
    v_xor_b32 v15, v15, v11
    v_lshlrev_b32 v15, 4, v15
    v_lshlrev_b32 v11, 10, v11
    v_add_u32 v11, 131072, v11
    v_xor_b32 v12, 0, v15
    v_add_u32 v12, v12, v11
    v_xor_b32 v13, 64, v15
    v_add_u32 v13, v13, v11
    v_xor_b32 v14, 128, v15
    v_add_u32 v14, v14, v11
    v_xor_b32 v15, 192, v15
    v_add_u32 v15, v15, v11
    s_add_u32 s48, s58, 0
    s_and_b32 s48, s48, 7
    s_lshl_b32 s48, s48, 14
    s_add_u32 m0, s49, 0
    s_nop 0
    buffer_load_dwordx4 v1, s[28:31], s48 offen offset:0 nt lds
    buffer_load_dwordx4 v2, s[28:31], s48 offen offset:1024 nt lds
    buffer_load_dwordx4 v3, s[28:31], s48 offen offset:2048 nt lds
    buffer_load_dwordx4 v4, s[28:31], s48 offen offset:3072 nt lds
    s_barrier
    s_barrier
    s_add_u32 s48, s58, 1
    s_and_b32 s48, s48, 7
    s_lshl_b32 s48, s48, 14
    s_add_u32 m0, s49, 16384
    s_nop 0
    buffer_load_dwordx4 v1, s[28:31], s48 offen offset:0 nt lds
    buffer_load_dwordx4 v2, s[28:31], s48 offen offset:1024 nt lds
    buffer_load_dwordx4 v3, s[28:31], s48 offen offset:2048 nt lds
    buffer_load_dwordx4 v4, s[28:31], s48 offen offset:3072 nt lds
    s_add_u32 s48, s58, 0
    s_and_b32 s48, s48, 7
    s_lshl_b32 s48, s48, 14
    s_add_u32 m0, s49, 32768
    s_nop 0
    buffer_load_dwordx4 v5, s[32:35], s48 offen offset:0 nt lds
    buffer_load_dwordx4 v5, s[32:35], s48 offen offset:1024 nt lds
    buffer_load_dwordx4 v5, s[32:35], s48 offen offset:2048 nt lds
    buffer_load_dwordx4 v5, s[32:35], s48 offen offset:3072 nt lds
    s_add_u32 s48, s58, 2
    s_and_b32 s48, s48, 7
    s_lshl_b32 s48, s48, 14
    s_add_u32 m0, s49, 49152
    s_nop 0
    buffer_load_dwordx4 v1, s[28:31], s48 offen offset:0 nt lds
    buffer_load_dwordx4 v2, s[28:31], s48 offen offset:1024 nt lds
    buffer_load_dwordx4 v3, s[28:31], s48 offen offset:2048 nt lds
    buffer_load_dwordx4 v4, s[28:31], s48 offen offset:3072 nt lds
    s_add_u32 s48, s58, 1
    s_and_b32 s48, s48, 7
    s_lshl_b32 s48, s48, 14
    s_add_u32 m0, s49, 65536
    s_nop 0
    buffer_load_dwordx4 v5, s[32:35], s48 offen offset:0 nt lds
    buffer_load_dwordx4 v5, s[32:35], s48 offen offset:1024 nt lds
    buffer_load_dwordx4 v5, s[32:35], s48 offen offset:2048 nt lds
    buffer_load_dwordx4 v5, s[32:35], s48 offen offset:3072 nt lds
    s_waitcnt vmcnt(12)
    s_barrier
    s_add_u32 s48, s58, 3
    s_and_b32 s48, s48, 7
    s_lshl_b32 s48, s48, 14
    s_add_u32 m0, s49, 81920
    s_nop 0
    buffer_load_dwordx4 v1, s[28:31], s48 offen offset:0 nt lds
    buffer_load_dwordx4 v2, s[28:31], s48 offen offset:1024 nt lds
    buffer_load_dwordx4 v3, s[28:31], s48 offen offset:2048 nt lds
    buffer_load_dwordx4 v4, s[28:31], s48 offen offset:3072 nt lds
    s_waitcnt vmcnt(12)
    s_barrier
    s_add_u32 s48, s58, 2
    s_and_b32 s48, s48, 7
    s_lshl_b32 s48, s48, 14
    s_add_u32 m0, s49, 98304
    s_nop 0
    buffer_load_dwordx4 v5, s[32:35], s48 offen offset:0 nt lds
    buffer_load_dwordx4 v5, s[32:35], s48 offen offset:1024 nt lds
    buffer_load_dwordx4 v5, s[32:35], s48 offen offset:2048 nt lds
    buffer_load_dwordx4 v5, s[32:35], s48 offen offset:3072 nt lds
    s_waitcnt vmcnt(12)
    s_barrier
    s_add_u32 s48, s58, 4
    s_and_b32 s48, s48, 7
    s_lshl_b32 s48, s48, 14
    s_add_u32 m0, s49, 114688
    s_nop 0
    buffer_load_dwordx4 v1, s[28:31], s48 offen offset:0 nt lds
    buffer_load_dwordx4 v2, s[28:31], s48 offen offset:1024 nt lds
    buffer_load_dwordx4 v3, s[28:31], s48 offen offset:2048 nt lds
    buffer_load_dwordx4 v4, s[28:31], s48 offen offset:3072 nt lds
    s_waitcnt vmcnt(12)
    s_barrier
    s_add_u32 s48, s58, 3
    s_and_b32 s48, s48, 7
    s_lshl_b32 s48, s48, 14
    buffer_load_dwordx4 v[128:131], v5, s[32:35], s48 offen offset:0 nt
    buffer_load_dwordx4 v[132:135], v5, s[32:35], s48 offen offset:1024 nt
    buffer_load_dwordx4 v[136:139], v5, s[32:35], s48 offen offset:2048 nt
    buffer_load_dwordx4 v[140:143], v5, s[32:35], s48 offen offset:3072 nt
    s_waitcnt vmcnt(12)
    s_barrier
    s_add_u32 s48, s58, 5
    s_and_b32 s48, s48, 7
    s_lshl_b32 s48, s48, 14
    buffer_load_dwordx4 v[144:147], v1, s[28:31], s48 offen offset:0 nt
    buffer_load_dwordx4 v[148:151], v2, s[28:31], s48 offen offset:1024 nt
    buffer_load_dwordx4 v[152:155], v3, s[28:31], s48 offen offset:2048 nt
    buffer_load_dwordx4 v[156:159], v4, s[28:31], s48 offen offset:3072 nt
    s_waitcnt vmcnt(12)
    s_barrier
    s_add_u32 s48, s58, 4
    s_and_b32 s48, s48, 7
    s_lshl_b32 s48, s48, 14
    buffer_load_dwordx4 v[160:163], v5, s[32:35], s48 offen offset:0 nt
    buffer_load_dwordx4 v[164:167], v5, s[32:35], s48 offen offset:1024 nt
    buffer_load_dwordx4 v[168:171], v5, s[32:35], s48 offen offset:2048 nt
    buffer_load_dwordx4 v[172:175], v5, s[32:35], s48 offen offset:3072 nt
    s_waitcnt vmcnt(12)
    s_barrier
    s_add_u32 s48, s58, 6
    s_and_b32 s48, s48, 7
    s_lshl_b32 s48, s48, 14
    buffer_load_dwordx4 v[176:179], v1, s[28:31], s48 offen offset:0 nt
    buffer_load_dwordx4 v[180:183], v2, s[28:31], s48 offen offset:1024 nt
    buffer_load_dwordx4 v[184:187], v3, s[28:31], s48 offen offset:2048 nt
    buffer_load_dwordx4 v[188:191], v4, s[28:31], s48 offen offset:3072 nt
    s_waitcnt vmcnt(12)
    ds_write_b128 v9, v[128:131] offset:0
    ds_write_b128 v9, v[132:135] offset:1024
    ds_write_b128 v9, v[136:139] offset:2048
    ds_write_b128 v9, v[140:143] offset:3072
    s_waitcnt lgkmcnt(0)
    s_barrier
    s_add_u32 s48, s58, 5
    s_and_b32 s48, s48, 7
    s_lshl_b32 s48, s48, 14
    buffer_load_dwordx4 v[192:195], v5, s[32:35], s48 offen offset:0 nt
    buffer_load_dwordx4 v[196:199], v5, s[32:35], s48 offen offset:1024 nt
    buffer_load_dwordx4 v[200:203], v5, s[32:35], s48 offen offset:2048 nt
    buffer_load_dwordx4 v[204:207], v5, s[32:35], s48 offen offset:3072 nt
    s_waitcnt vmcnt(12)
    ds_write_b128 v9, v[144:147] offset:16384
    ds_write_b128 v9, v[148:151] offset:17408
    ds_write_b128 v9, v[152:155] offset:18432
    ds_write_b128 v9, v[156:159] offset:19456
    s_waitcnt lgkmcnt(0)
    s_barrier
    s_add_u32 s48, s58, 7
    s_and_b32 s48, s48, 7
    s_lshl_b32 s48, s48, 14
    buffer_load_dwordx4 v[208:211], v1, s[28:31], s48 offen offset:0 nt
    buffer_load_dwordx4 v[212:215], v2, s[28:31], s48 offen offset:1024 nt
    buffer_load_dwordx4 v[216:219], v3, s[28:31], s48 offen offset:2048 nt
    buffer_load_dwordx4 v[220:223], v4, s[28:31], s48 offen offset:3072 nt
    s_waitcnt vmcnt(12)
    ds_write_b128 v9, v[160:163] offset:32768
    ds_write_b128 v9, v[164:167] offset:33792
    ds_write_b128 v9, v[168:171] offset:34816
    ds_write_b128 v9, v[172:175] offset:35840
    s_waitcnt lgkmcnt(0)
    s_barrier
    s_add_u32 s48, s58, 6
    s_and_b32 s48, s48, 7
    s_lshl_b32 s48, s48, 14
    buffer_load_dwordx4 v[224:227], v5, s[32:35], s48 offen offset:0 nt
    buffer_load_dwordx4 v[228:231], v5, s[32:35], s48 offen offset:1024 nt
    buffer_load_dwordx4 v[232:235], v5, s[32:35], s48 offen offset:2048 nt
    buffer_load_dwordx4 v[236:239], v5, s[32:35], s48 offen offset:3072 nt
    s_waitcnt vmcnt(12)
    ds_write_b128 v9, v[176:179] offset:49152
    ds_write_b128 v9, v[180:183] offset:50176
    ds_write_b128 v9, v[184:187] offset:51200
    ds_write_b128 v9, v[188:191] offset:52224
    s_waitcnt lgkmcnt(0)
    s_barrier
    s_add_u32 s48, s58, 7
    s_and_b32 s48, s48, 7
    s_lshl_b32 s48, s48, 14
    buffer_load_dwordx4 v[240:243], v5, s[32:35], s48 offen offset:0 nt
    buffer_load_dwordx4 v[244:247], v5, s[32:35], s48 offen offset:1024 nt
    buffer_load_dwordx4 v[248:251], v5, s[32:35], s48 offen offset:2048 nt
    buffer_load_dwordx4 v[252:255], v5, s[32:35], s48 offen offset:3072 nt
    s_waitcnt vmcnt(12)
    ds_write_b128 v10, v[192:195] offset:0
    ds_write_b128 v10, v[196:199] offset:1024
    ds_write_b128 v10, v[200:203] offset:2048
    ds_write_b128 v10, v[204:207] offset:3072
    s_waitcnt lgkmcnt(0)
    s_mov_b32 s48, 0
    buffer_load_dwordx4 v[16:19], v6, s[40:43], s48 offen offset:0
    buffer_load_dwordx4 v[20:23], v6, s[40:43], s48 offen offset:1024
    buffer_load_dwordx4 v[24:27], v6, s[40:43], s48 offen offset:2048
    buffer_load_dwordx4 v[28:31], v6, s[40:43], s48 offen offset:3072
    buffer_load_dwordx4 v[32:35], v7, s[40:43], s48 offen offset:0
    buffer_load_dwordx4 v[36:39], v7, s[40:43], s48 offen offset:1024
    buffer_load_dwordx4 v[40:43], v7, s[40:43], s48 offen offset:2048
    buffer_load_dwordx4 v[44:47], v7, s[40:43], s48 offen offset:3072
    s_barrier
    s_waitcnt vmcnt(16)
    ds_write_b128 v10, v[208:211] offset:16384
    ds_write_b128 v10, v[212:215] offset:17408
    ds_write_b128 v10, v[216:219] offset:18432
    ds_write_b128 v10, v[220:223] offset:19456
    s_waitcnt lgkmcnt(0)
    s_mov_b32 s48, 32768
    buffer_load_dwordx4 v[48:51], v6, s[40:43], s48 offen offset:0
    buffer_load_dwordx4 v[52:55], v6, s[40:43], s48 offen offset:1024
    buffer_load_dwordx4 v[56:59], v6, s[40:43], s48 offen offset:2048
    buffer_load_dwordx4 v[60:63], v6, s[40:43], s48 offen offset:3072
    buffer_load_dwordx4 v[64:67], v7, s[40:43], s48 offen offset:0
    buffer_load_dwordx4 v[68:71], v7, s[40:43], s48 offen offset:1024
    buffer_load_dwordx4 v[72:75], v7, s[40:43], s48 offen offset:2048
    buffer_load_dwordx4 v[76:79], v7, s[40:43], s48 offen offset:3072
    s_barrier
    s_waitcnt vmcnt(20)
    ds_write_b128 v10, v[224:227] offset:32768
    ds_write_b128 v10, v[228:231] offset:33792
    ds_write_b128 v10, v[232:235] offset:34816
    ds_write_b128 v10, v[236:239] offset:35840
    s_waitcnt lgkmcnt(0)
    s_mov_b32 s48, 65536
    buffer_load_dwordx4 v[80:83], v6, s[40:43], s48 offen offset:0
    buffer_load_dwordx4 v[84:87], v6, s[40:43], s48 offen offset:1024
    buffer_load_dwordx4 v[88:91], v6, s[40:43], s48 offen offset:2048
    buffer_load_dwordx4 v[92:95], v6, s[40:43], s48 offen offset:3072
    buffer_load_dwordx4 v[96:99], v7, s[40:43], s48 offen offset:0
    buffer_load_dwordx4 v[100:103], v7, s[40:43], s48 offen offset:1024
    buffer_load_dwordx4 v[104:107], v7, s[40:43], s48 offen offset:2048
    buffer_load_dwordx4 v[108:111], v7, s[40:43], s48 offen offset:3072
    s_barrier
    s_waitcnt vmcnt(24)
    ds_write_b128 v10, v[240:243] offset:49152
    ds_write_b128 v10, v[244:247] offset:50176
    ds_write_b128 v10, v[248:251] offset:51200
    ds_write_b128 v10, v[252:255] offset:52224
    s_waitcnt lgkmcnt(0)
    s_barrier
    s_mov_b32 s48, 98304
    buffer_load_dwordx4 v[224:227], v6, s[40:43], s48 offen offset:0
    buffer_load_dwordx4 v[228:231], v6, s[40:43], s48 offen offset:1024
    buffer_load_dwordx4 v[232:235], v6, s[40:43], s48 offen offset:2048
    buffer_load_dwordx4 v[236:239], v6, s[40:43], s48 offen offset:3072
    buffer_load_dwordx4 v[240:243], v7, s[40:43], s48 offen offset:0
    buffer_load_dwordx4 v[244:247], v7, s[40:43], s48 offen offset:1024
    buffer_load_dwordx4 v[248:251], v7, s[40:43], s48 offen offset:2048
    buffer_load_dwordx4 v[252:255], v7, s[40:43], s48 offen offset:3072
    s_barrier
    s_barrier
    ds_read_b128 v[112:115], v12 offset:0
    ds_read_b128 v[116:119], v12 offset:16384
    ds_read_b128 v[120:123], v13 offset:0
    ds_read_b128 v[124:127], v13 offset:16384
    s_waitcnt vmcnt(24)
    v_perm_b32 v192, v20, v16, s54
    v_perm_b32 v193, v28, v24, s54
    v_perm_b32 v194, v36, v32, s54
    v_perm_b32 v195, v44, v40, s54
    v_perm_b32 v196, v20, v16, s55
    v_perm_b32 v197, v28, v24, s55
    s_waitcnt lgkmcnt(2)
    v_mfma_f32_16x16x32_bf16 v[128:131], v[192:195], v[112:115], 0
    v_perm_b32 v198, v36, v32, s55
    v_perm_b32 v199, v44, v40, s55
    v_mfma_f32_16x16x32_bf16 v[132:135], v[192:195], v[116:119], 0
    v_perm_b32 v200, v21, v17, s54
    v_perm_b32 v201, v29, v25, s54
    v_mfma_f32_16x16x32_bf16 v[136:139], v[196:199], v[112:115], 0
    v_perm_b32 v202, v37, v33, s54
    v_perm_b32 v203, v45, v41, s54
    v_mfma_f32_16x16x32_bf16 v[140:143], v[196:199], v[116:119], 0
    v_perm_b32 v204, v21, v17, s55
    v_perm_b32 v205, v29, v25, s55
    v_mfma_f32_16x16x32_bf16 v[144:147], v[200:203], v[112:115], 0
    v_perm_b32 v206, v37, v33, s55
    v_perm_b32 v207, v45, v41, s55
    v_mfma_f32_16x16x32_bf16 v[148:151], v[200:203], v[116:119], 0
    v_perm_b32 v208, v22, v18, s54
    v_perm_b32 v209, v30, v26, s54
    v_mfma_f32_16x16x32_bf16 v[152:155], v[204:207], v[112:115], 0
    v_perm_b32 v210, v38, v34, s54
    v_perm_b32 v211, v46, v42, s54
    v_mfma_f32_16x16x32_bf16 v[156:159], v[204:207], v[116:119], 0
    v_perm_b32 v212, v22, v18, s55
    v_perm_b32 v213, v30, v26, s55
    v_mfma_f32_16x16x32_bf16 v[160:163], v[208:211], v[112:115], 0
    v_perm_b32 v214, v38, v34, s55
    v_perm_b32 v215, v46, v42, s55
    v_mfma_f32_16x16x32_bf16 v[164:167], v[208:211], v[116:119], 0
    v_perm_b32 v216, v23, v19, s54
    v_perm_b32 v217, v31, v27, s54
    v_mfma_f32_16x16x32_bf16 v[168:171], v[212:215], v[112:115], 0
    v_perm_b32 v218, v39, v35, s54
    v_perm_b32 v219, v47, v43, s54
    v_mfma_f32_16x16x32_bf16 v[172:175], v[212:215], v[116:119], 0
    v_perm_b32 v220, v23, v19, s55
    v_perm_b32 v221, v31, v27, s55
    v_mfma_f32_16x16x32_bf16 v[176:179], v[216:219], v[112:115], 0
    v_perm_b32 v222, v39, v35, s55
    v_perm_b32 v223, v47, v43, s55
    v_mfma_f32_16x16x32_bf16 v[180:183], v[216:219], v[116:119], 0
    s_waitcnt vmcnt(16)
    v_perm_b32 v192, v52, v48, s54
    v_perm_b32 v193, v60, v56, s54
    v_mfma_f32_16x16x32_bf16 v[184:187], v[220:223], v[112:115], 0
    v_perm_b32 v194, v68, v64, s54
    v_perm_b32 v195, v76, v72, s54
    v_mfma_f32_16x16x32_bf16 v[188:191], v[220:223], v[116:119], 0
    ds_read_b128 v[112:115], v14 offset:0
    ds_read_b128 v[116:119], v14 offset:16384
    v_perm_b32 v196, v52, v48, s55
    v_perm_b32 v197, v60, v56, s55
    s_waitcnt lgkmcnt(2)
    v_mfma_f32_16x16x32_bf16 v[128:131], v[192:195], v[120:123], v[128:131]
    s_mov_b32 s48, 131072
    buffer_load_dwordx4 v[16:19], v6, s[40:43], s48 offen offset:0
    v_perm_b32 v198, v68, v64, s55
    v_perm_b32 v199, v76, v72, s55
    v_mfma_f32_16x16x32_bf16 v[132:135], v[192:195], v[124:127], v[132:135]
    v_perm_b32 v200, v53, v49, s54
    v_perm_b32 v201, v61, v57, s54
    v_mfma_f32_16x16x32_bf16 v[136:139], v[196:199], v[120:123], v[136:139]
    buffer_load_dwordx4 v[20:23], v6, s[40:43], s48 offen offset:1024
    v_perm_b32 v202, v69, v65, s54
    v_perm_b32 v203, v77, v73, s54
    v_mfma_f32_16x16x32_bf16 v[140:143], v[196:199], v[124:127], v[140:143]
    v_perm_b32 v204, v53, v49, s55
    v_perm_b32 v205, v61, v57, s55
    v_mfma_f32_16x16x32_bf16 v[144:147], v[200:203], v[120:123], v[144:147]
    buffer_load_dwordx4 v[24:27], v6, s[40:43], s48 offen offset:2048
    v_perm_b32 v206, v69, v65, s55
    v_perm_b32 v207, v77, v73, s55
    v_mfma_f32_16x16x32_bf16 v[148:151], v[200:203], v[124:127], v[148:151]
    v_perm_b32 v208, v54, v50, s54
    v_perm_b32 v209, v62, v58, s54
    v_mfma_f32_16x16x32_bf16 v[152:155], v[204:207], v[120:123], v[152:155]
    buffer_load_dwordx4 v[28:31], v6, s[40:43], s48 offen offset:3072
    v_perm_b32 v210, v70, v66, s54
    v_perm_b32 v211, v78, v74, s54
    v_mfma_f32_16x16x32_bf16 v[156:159], v[204:207], v[124:127], v[156:159]
    v_perm_b32 v212, v54, v50, s55
    v_perm_b32 v213, v62, v58, s55
    v_mfma_f32_16x16x32_bf16 v[160:163], v[208:211], v[120:123], v[160:163]
    buffer_load_dwordx4 v[32:35], v7, s[40:43], s48 offen offset:0
    v_perm_b32 v214, v70, v66, s55
    v_perm_b32 v215, v78, v74, s55
    v_mfma_f32_16x16x32_bf16 v[164:167], v[208:211], v[124:127], v[164:167]
    v_perm_b32 v216, v55, v51, s54
    v_perm_b32 v217, v63, v59, s54
    v_mfma_f32_16x16x32_bf16 v[168:171], v[212:215], v[120:123], v[168:171]
    buffer_load_dwordx4 v[36:39], v7, s[40:43], s48 offen offset:1024
    v_perm_b32 v218, v71, v67, s54
    v_perm_b32 v219, v79, v75, s54
    v_mfma_f32_16x16x32_bf16 v[172:175], v[212:215], v[124:127], v[172:175]
    v_perm_b32 v220, v55, v51, s55
    v_perm_b32 v221, v63, v59, s55
    v_mfma_f32_16x16x32_bf16 v[176:179], v[216:219], v[120:123], v[176:179]
    buffer_load_dwordx4 v[40:43], v7, s[40:43], s48 offen offset:2048
    v_perm_b32 v222, v71, v67, s55
    v_perm_b32 v223, v79, v75, s55
    v_mfma_f32_16x16x32_bf16 v[180:183], v[216:219], v[124:127], v[180:183]
    s_waitcnt vmcnt(15)
    v_perm_b32 v192, v84, v80, s54
    v_perm_b32 v193, v92, v88, s54
    v_mfma_f32_16x16x32_bf16 v[184:187], v[220:223], v[120:123], v[184:187]
    buffer_load_dwordx4 v[44:47], v7, s[40:43], s48 offen offset:3072
    v_perm_b32 v194, v100, v96, s54
    v_perm_b32 v195, v108, v104, s54
    v_mfma_f32_16x16x32_bf16 v[188:191], v[220:223], v[124:127], v[188:191]
    ds_read_b128 v[120:123], v15 offset:0
    ds_read_b128 v[124:127], v15 offset:16384
    v_perm_b32 v196, v84, v80, s55
    v_perm_b32 v197, v92, v88, s55
    s_waitcnt lgkmcnt(2)
    v_mfma_f32_16x16x32_bf16 v[128:131], v[192:195], v[112:115], v[128:131]
    s_mov_b32 s48, 163840
    buffer_load_dwordx4 v[48:51], v6, s[40:43], s48 offen offset:0
    v_perm_b32 v198, v100, v96, s55
    v_perm_b32 v199, v108, v104, s55
    v_mfma_f32_16x16x32_bf16 v[132:135], v[192:195], v[116:119], v[132:135]
    v_perm_b32 v200, v85, v81, s54
    v_perm_b32 v201, v93, v89, s54
    v_mfma_f32_16x16x32_bf16 v[136:139], v[196:199], v[112:115], v[136:139]
    buffer_load_dwordx4 v[52:55], v6, s[40:43], s48 offen offset:1024
    v_perm_b32 v202, v101, v97, s54
    v_perm_b32 v203, v109, v105, s54
    v_mfma_f32_16x16x32_bf16 v[140:143], v[196:199], v[116:119], v[140:143]
    v_perm_b32 v204, v85, v81, s55
    v_perm_b32 v205, v93, v89, s55
    v_mfma_f32_16x16x32_bf16 v[144:147], v[200:203], v[112:115], v[144:147]
    buffer_load_dwordx4 v[56:59], v6, s[40:43], s48 offen offset:2048
    v_perm_b32 v206, v101, v97, s55
    v_perm_b32 v207, v109, v105, s55
    v_mfma_f32_16x16x32_bf16 v[148:151], v[200:203], v[116:119], v[148:151]
    v_perm_b32 v208, v86, v82, s54
    v_perm_b32 v209, v94, v90, s54
    v_mfma_f32_16x16x32_bf16 v[152:155], v[204:207], v[112:115], v[152:155]
    buffer_load_dwordx4 v[60:63], v6, s[40:43], s48 offen offset:3072
    v_perm_b32 v210, v102, v98, s54
    v_perm_b32 v211, v110, v106, s54
    v_mfma_f32_16x16x32_bf16 v[156:159], v[204:207], v[116:119], v[156:159]
    v_perm_b32 v212, v86, v82, s55
    v_perm_b32 v213, v94, v90, s55
    v_mfma_f32_16x16x32_bf16 v[160:163], v[208:211], v[112:115], v[160:163]
    buffer_load_dwordx4 v[64:67], v7, s[40:43], s48 offen offset:0
    v_perm_b32 v214, v102, v98, s55
    v_perm_b32 v215, v110, v106, s55
    v_mfma_f32_16x16x32_bf16 v[164:167], v[208:211], v[116:119], v[164:167]
    v_perm_b32 v216, v87, v83, s54
    v_perm_b32 v217, v95, v91, s54
    v_mfma_f32_16x16x32_bf16 v[168:171], v[212:215], v[112:115], v[168:171]
    buffer_load_dwordx4 v[68:71], v7, s[40:43], s48 offen offset:1024
    v_perm_b32 v218, v103, v99, s54
    v_perm_b32 v219, v111, v107, s54
    v_mfma_f32_16x16x32_bf16 v[172:175], v[212:215], v[116:119], v[172:175]
    v_perm_b32 v220, v87, v83, s55
    v_perm_b32 v221, v95, v91, s55
    v_mfma_f32_16x16x32_bf16 v[176:179], v[216:219], v[112:115], v[176:179]
    buffer_load_dwordx4 v[72:75], v7, s[40:43], s48 offen offset:2048
    v_perm_b32 v222, v103, v99, s55
    v_perm_b32 v223, v111, v107, s55
    v_mfma_f32_16x16x32_bf16 v[180:183], v[216:219], v[116:119], v[180:183]
    s_waitcnt vmcnt(15)
    v_perm_b32 v192, v228, v224, s54
    v_perm_b32 v193, v236, v232, s54
    v_mfma_f32_16x16x32_bf16 v[184:187], v[220:223], v[112:115], v[184:187]
    buffer_load_dwordx4 v[76:79], v7, s[40:43], s48 offen offset:3072
    v_perm_b32 v194, v244, v240, s54
    v_perm_b32 v195, v252, v248, s54
    v_mfma_f32_16x16x32_bf16 v[188:191], v[220:223], v[116:119], v[188:191]
    ds_read_b128 v[112:115], v12 offset:256
    ds_read_b128 v[116:119], v12 offset:16640
    v_perm_b32 v196, v228, v224, s55
    v_perm_b32 v197, v236, v232, s55
    s_waitcnt lgkmcnt(2)
    v_mfma_f32_16x16x32_bf16 v[128:131], v[192:195], v[120:123], v[128:131]
    s_mov_b32 s48, 196608
    buffer_load_dwordx4 v[80:83], v6, s[40:43], s48 offen offset:0
    v_perm_b32 v198, v244, v240, s55
    v_perm_b32 v199, v252, v248, s55
    v_mfma_f32_16x16x32_bf16 v[132:135], v[192:195], v[124:127], v[132:135]
    v_perm_b32 v200, v229, v225, s54
    v_perm_b32 v201, v237, v233, s54
    v_mfma_f32_16x16x32_bf16 v[136:139], v[196:199], v[120:123], v[136:139]
    buffer_load_dwordx4 v[84:87], v6, s[40:43], s48 offen offset:1024
    v_perm_b32 v202, v245, v241, s54
    v_perm_b32 v203, v253, v249, s54
    v_mfma_f32_16x16x32_bf16 v[140:143], v[196:199], v[124:127], v[140:143]
    v_perm_b32 v204, v229, v225, s55
    v_perm_b32 v205, v237, v233, s55
    v_mfma_f32_16x16x32_bf16 v[144:147], v[200:203], v[120:123], v[144:147]
    buffer_load_dwordx4 v[88:91], v6, s[40:43], s48 offen offset:2048
    v_perm_b32 v206, v245, v241, s55
    v_perm_b32 v207, v253, v249, s55
    v_mfma_f32_16x16x32_bf16 v[148:151], v[200:203], v[124:127], v[148:151]
    v_perm_b32 v208, v230, v226, s54
    v_perm_b32 v209, v238, v234, s54
    v_mfma_f32_16x16x32_bf16 v[152:155], v[204:207], v[120:123], v[152:155]
    buffer_load_dwordx4 v[92:95], v6, s[40:43], s48 offen offset:3072
    v_perm_b32 v210, v246, v242, s54
    v_perm_b32 v211, v254, v250, s54
    v_mfma_f32_16x16x32_bf16 v[156:159], v[204:207], v[124:127], v[156:159]
    v_perm_b32 v212, v230, v226, s55
    v_perm_b32 v213, v238, v234, s55
    v_mfma_f32_16x16x32_bf16 v[160:163], v[208:211], v[120:123], v[160:163]
    buffer_load_dwordx4 v[96:99], v7, s[40:43], s48 offen offset:0
    v_perm_b32 v214, v246, v242, s55
    v_perm_b32 v215, v254, v250, s55
    v_mfma_f32_16x16x32_bf16 v[164:167], v[208:211], v[124:127], v[164:167]
    v_perm_b32 v216, v231, v227, s54
    v_perm_b32 v217, v239, v235, s54
    v_mfma_f32_16x16x32_bf16 v[168:171], v[212:215], v[120:123], v[168:171]
    buffer_load_dwordx4 v[100:103], v7, s[40:43], s48 offen offset:1024
    v_perm_b32 v218, v247, v243, s54
    v_perm_b32 v219, v255, v251, s54
    v_mfma_f32_16x16x32_bf16 v[172:175], v[212:215], v[124:127], v[172:175]
    v_perm_b32 v220, v231, v227, s55
    v_perm_b32 v221, v239, v235, s55
    v_mfma_f32_16x16x32_bf16 v[176:179], v[216:219], v[120:123], v[176:179]
    buffer_load_dwordx4 v[104:107], v7, s[40:43], s48 offen offset:2048
    v_perm_b32 v222, v247, v243, s55
    v_perm_b32 v223, v255, v251, s55
    v_mfma_f32_16x16x32_bf16 v[180:183], v[216:219], v[124:127], v[180:183]
    s_waitcnt vmcnt(15)
    v_perm_b32 v192, v20, v16, s54
    v_perm_b32 v193, v28, v24, s54
    v_mfma_f32_16x16x32_bf16 v[184:187], v[220:223], v[120:123], v[184:187]
    buffer_load_dwordx4 v[108:111], v7, s[40:43], s48 offen offset:3072
    v_perm_b32 v194, v36, v32, s54
    v_perm_b32 v195, v44, v40, s54
    v_mfma_f32_16x16x32_bf16 v[188:191], v[220:223], v[124:127], v[188:191]
    ds_read_b128 v[120:123], v13 offset:256
    ds_read_b128 v[124:127], v13 offset:16640
    v_perm_b32 v196, v20, v16, s55
    v_perm_b32 v197, v28, v24, s55
    s_waitcnt lgkmcnt(2)
    v_mfma_f32_16x16x32_bf16 v[128:131], v[192:195], v[112:115], v[128:131]
    v_perm_b32 v198, v36, v32, s55
    v_perm_b32 v199, v44, v40, s55
    v_mfma_f32_16x16x32_bf16 v[132:135], v[192:195], v[116:119], v[132:135]
    v_perm_b32 v200, v21, v17, s54
    v_perm_b32 v201, v29, v25, s54
    v_mfma_f32_16x16x32_bf16 v[136:139], v[196:199], v[112:115], v[136:139]
    v_perm_b32 v202, v37, v33, s54
    v_perm_b32 v203, v45, v41, s54
    v_mfma_f32_16x16x32_bf16 v[140:143], v[196:199], v[116:119], v[140:143]
    v_perm_b32 v204, v21, v17, s55
    v_perm_b32 v205, v29, v25, s55
    v_mfma_f32_16x16x32_bf16 v[144:147], v[200:203], v[112:115], v[144:147]
    v_perm_b32 v206, v37, v33, s55
    v_perm_b32 v207, v45, v41, s55
    v_mfma_f32_16x16x32_bf16 v[148:151], v[200:203], v[116:119], v[148:151]
    v_perm_b32 v208, v22, v18, s54
    v_perm_b32 v209, v30, v26, s54
    v_mfma_f32_16x16x32_bf16 v[152:155], v[204:207], v[112:115], v[152:155]
    v_perm_b32 v210, v38, v34, s54
    v_perm_b32 v211, v46, v42, s54
    v_mfma_f32_16x16x32_bf16 v[156:159], v[204:207], v[116:119], v[156:159]
    v_perm_b32 v212, v22, v18, s55
    v_perm_b32 v213, v30, v26, s55
    v_mfma_f32_16x16x32_bf16 v[160:163], v[208:211], v[112:115], v[160:163]
    v_perm_b32 v214, v38, v34, s55
    v_perm_b32 v215, v46, v42, s55
    v_mfma_f32_16x16x32_bf16 v[164:167], v[208:211], v[116:119], v[164:167]
    v_perm_b32 v216, v23, v19, s54
    v_perm_b32 v217, v31, v27, s54
    v_mfma_f32_16x16x32_bf16 v[168:171], v[212:215], v[112:115], v[168:171]
    v_perm_b32 v218, v39, v35, s54
    v_perm_b32 v219, v47, v43, s54
    v_mfma_f32_16x16x32_bf16 v[172:175], v[212:215], v[116:119], v[172:175]
    v_perm_b32 v220, v23, v19, s55
    v_perm_b32 v221, v31, v27, s55
    v_mfma_f32_16x16x32_bf16 v[176:179], v[216:219], v[112:115], v[176:179]
    v_perm_b32 v222, v39, v35, s55
    v_perm_b32 v223, v47, v43, s55
    v_mfma_f32_16x16x32_bf16 v[180:183], v[216:219], v[116:119], v[180:183]
    s_waitcnt vmcnt(8)
    v_perm_b32 v192, v52, v48, s54
    v_perm_b32 v193, v60, v56, s54
    v_mfma_f32_16x16x32_bf16 v[184:187], v[220:223], v[112:115], v[184:187]
    v_perm_b32 v194, v68, v64, s54
    v_perm_b32 v195, v76, v72, s54
    v_mfma_f32_16x16x32_bf16 v[188:191], v[220:223], v[116:119], v[188:191]
    ds_read_b128 v[112:115], v14 offset:256
    ds_read_b128 v[116:119], v14 offset:16640
    v_perm_b32 v196, v52, v48, s55
    v_perm_b32 v197, v60, v56, s55
    s_waitcnt lgkmcnt(2)
    v_mfma_f32_16x16x32_bf16 v[128:131], v[192:195], v[120:123], v[128:131]
    v_perm_b32 v198, v68, v64, s55
    v_perm_b32 v199, v76, v72, s55
    v_mfma_f32_16x16x32_bf16 v[132:135], v[192:195], v[124:127], v[132:135]
    v_perm_b32 v200, v53, v49, s54
    v_perm_b32 v201, v61, v57, s54
    v_mfma_f32_16x16x32_bf16 v[136:139], v[196:199], v[120:123], v[136:139]
    v_perm_b32 v202, v69, v65, s54
    v_perm_b32 v203, v77, v73, s54
    v_mfma_f32_16x16x32_bf16 v[140:143], v[196:199], v[124:127], v[140:143]
    v_perm_b32 v204, v53, v49, s55
    v_perm_b32 v205, v61, v57, s55
    v_mfma_f32_16x16x32_bf16 v[144:147], v[200:203], v[120:123], v[144:147]
    v_perm_b32 v206, v69, v65, s55
    v_perm_b32 v207, v77, v73, s55
    v_mfma_f32_16x16x32_bf16 v[148:151], v[200:203], v[124:127], v[148:151]
    v_perm_b32 v208, v54, v50, s54
    v_perm_b32 v209, v62, v58, s54
    v_mfma_f32_16x16x32_bf16 v[152:155], v[204:207], v[120:123], v[152:155]
    v_perm_b32 v210, v70, v66, s54
    v_perm_b32 v211, v78, v74, s54
    v_mfma_f32_16x16x32_bf16 v[156:159], v[204:207], v[124:127], v[156:159]
    v_perm_b32 v212, v54, v50, s55
    v_perm_b32 v213, v62, v58, s55
    v_mfma_f32_16x16x32_bf16 v[160:163], v[208:211], v[120:123], v[160:163]
    v_perm_b32 v214, v70, v66, s55
    v_perm_b32 v215, v78, v74, s55
    v_mfma_f32_16x16x32_bf16 v[164:167], v[208:211], v[124:127], v[164:167]
    v_perm_b32 v216, v55, v51, s54
    v_perm_b32 v217, v63, v59, s54
    v_mfma_f32_16x16x32_bf16 v[168:171], v[212:215], v[120:123], v[168:171]
    v_perm_b32 v218, v71, v67, s54
    v_perm_b32 v219, v79, v75, s54
    v_mfma_f32_16x16x32_bf16 v[172:175], v[212:215], v[124:127], v[172:175]
    v_perm_b32 v220, v55, v51, s55
    v_perm_b32 v221, v63, v59, s55
    v_mfma_f32_16x16x32_bf16 v[176:179], v[216:219], v[120:123], v[176:179]
    v_perm_b32 v222, v71, v67, s55
    v_perm_b32 v223, v79, v75, s55
    v_mfma_f32_16x16x32_bf16 v[180:183], v[216:219], v[124:127], v[180:183]
    s_waitcnt vmcnt(0)
    v_perm_b32 v192, v84, v80, s54
    v_perm_b32 v193, v92, v88, s54
    v_mfma_f32_16x16x32_bf16 v[184:187], v[220:223], v[120:123], v[184:187]
    v_perm_b32 v194, v100, v96, s54
    v_perm_b32 v195, v108, v104, s54
    v_mfma_f32_16x16x32_bf16 v[188:191], v[220:223], v[124:127], v[188:191]
    v_perm_b32 v196, v84, v80, s55
    v_perm_b32 v197, v92, v88, s55
    s_waitcnt lgkmcnt(0)
    v_mfma_f32_16x16x32_bf16 v[128:131], v[192:195], v[112:115], v[128:131]
    v_perm_b32 v198, v100, v96, s55
    v_perm_b32 v199, v108, v104, s55
    v_mfma_f32_16x16x32_bf16 v[132:135], v[192:195], v[116:119], v[132:135]
    v_perm_b32 v200, v85, v81, s54
    v_perm_b32 v201, v93, v89, s54
    v_mfma_f32_16x16x32_bf16 v[136:139], v[196:199], v[112:115], v[136:139]
    v_perm_b32 v202, v101, v97, s54
    v_perm_b32 v203, v109, v105, s54
    v_mfma_f32_16x16x32_bf16 v[140:143], v[196:199], v[116:119], v[140:143]
    v_perm_b32 v204, v85, v81, s55
    v_perm_b32 v205, v93, v89, s55
    v_mfma_f32_16x16x32_bf16 v[144:147], v[200:203], v[112:115], v[144:147]
    v_perm_b32 v206, v101, v97, s55
    v_perm_b32 v207, v109, v105, s55
    v_mfma_f32_16x16x32_bf16 v[148:151], v[200:203], v[116:119], v[148:151]
    v_perm_b32 v208, v86, v82, s54
    v_perm_b32 v209, v94, v90, s54
    v_mfma_f32_16x16x32_bf16 v[152:155], v[204:207], v[112:115], v[152:155]
    v_perm_b32 v210, v102, v98, s54
    v_perm_b32 v211, v110, v106, s54
    v_mfma_f32_16x16x32_bf16 v[156:159], v[204:207], v[116:119], v[156:159]
    v_perm_b32 v212, v86, v82, s55
    v_perm_b32 v213, v94, v90, s55
    v_mfma_f32_16x16x32_bf16 v[160:163], v[208:211], v[112:115], v[160:163]
    v_perm_b32 v214, v102, v98, s55
    v_perm_b32 v215, v110, v106, s55
    v_mfma_f32_16x16x32_bf16 v[164:167], v[208:211], v[116:119], v[164:167]
    v_perm_b32 v216, v87, v83, s54
    v_perm_b32 v217, v95, v91, s54
    v_mfma_f32_16x16x32_bf16 v[168:171], v[212:215], v[112:115], v[168:171]
    v_perm_b32 v218, v103, v99, s54
    v_perm_b32 v219, v111, v107, s54
    v_mfma_f32_16x16x32_bf16 v[172:175], v[212:215], v[116:119], v[172:175]
    v_perm_b32 v220, v87, v83, s55
    v_perm_b32 v221, v95, v91, s55
    v_mfma_f32_16x16x32_bf16 v[176:179], v[216:219], v[112:115], v[176:179]
    v_perm_b32 v222, v103, v99, s55
    v_perm_b32 v223, v111, v107, s55
    v_mfma_f32_16x16x32_bf16 v[180:183], v[216:219], v[116:119], v[180:183]
    s_nop 0
    v_mfma_f32_16x16x32_bf16 v[184:187], v[220:223], v[112:115], v[184:187]
    v_mfma_f32_16x16x32_bf16 v[188:191], v[220:223], v[116:119], v[188:191]
    v_lshlrev_b32 v3, 4, v8
    s_lshl_b32 s51, s22, 13
    v_add_u32 v1, s51, v3
    s_xor_b32 s51, s51, 32768
    v_add_u32 v2, s51, v3
    ds_write_b128 v1, v[128:131] offset:0
    ds_write_b128 v1, v[136:139] offset:1024
    ds_write_b128 v1, v[144:147] offset:2048
    ds_write_b128 v1, v[152:155] offset:3072
    ds_write_b128 v1, v[160:163] offset:4096
    ds_write_b128 v1, v[168:171] offset:5120
    ds_write_b128 v1, v[176:179] offset:6144
    ds_write_b128 v1, v[184:187] offset:7168
    s_lshl_b32 s51, s22, 12
    s_nop 0
    v_add_u32 v1, s51, v3
    s_lshl_b32 s52, s21, 15
    s_waitcnt lgkmcnt(0)
    s_barrier
    ds_read_b128 v[16:19], v2 offset:0
    ds_read_b128 v[20:23], v2 offset:1024
    ds_read_b128 v[24:27], v2 offset:2048
    ds_read_b128 v[28:31], v2 offset:3072
    ds_read_b128 v[32:35], v2 offset:4096
    ds_read_b128 v[36:39], v2 offset:5120
    ds_read_b128 v[40:43], v2 offset:6144
    ds_read_b128 v[44:47], v2 offset:7168
    s_waitcnt lgkmcnt(7)
    v_add_f32 v132, v132, v16
    v_add_f32 v133, v133, v17
    v_add_f32 v134, v134, v18
    v_add_f32 v135, v135, v19
    s_waitcnt lgkmcnt(6)
    v_add_f32 v140, v140, v20
    v_add_f32 v141, v141, v21
    v_add_f32 v142, v142, v22
    v_add_f32 v143, v143, v23
    s_waitcnt lgkmcnt(5)
    v_add_f32 v148, v148, v24
    v_add_f32 v149, v149, v25
    v_add_f32 v150, v150, v26
    v_add_f32 v151, v151, v27
    s_waitcnt lgkmcnt(4)
    v_add_f32 v156, v156, v28
    v_add_f32 v157, v157, v29
    v_add_f32 v158, v158, v30
    v_add_f32 v159, v159, v31
    s_waitcnt lgkmcnt(3)
    v_add_f32 v164, v164, v32
    v_add_f32 v165, v165, v33
    v_add_f32 v166, v166, v34
    v_add_f32 v167, v167, v35
    s_waitcnt lgkmcnt(2)
    v_add_f32 v172, v172, v36
    v_add_f32 v173, v173, v37
    v_add_f32 v174, v174, v38
    v_add_f32 v175, v175, v39
    s_waitcnt lgkmcnt(1)
    v_add_f32 v180, v180, v40
    v_add_f32 v181, v181, v41
    v_add_f32 v182, v182, v42
    v_add_f32 v183, v183, v43
    s_waitcnt lgkmcnt(0)
    v_add_f32 v188, v188, v44
    v_add_f32 v189, v189, v45
    v_add_f32 v190, v190, v46
    v_add_f32 v191, v191, v47
    v_cvt_pk_bf16_f32 v48, v132, v140
    v_cvt_pk_bf16_f32 v49, v148, v156
    v_cvt_pk_bf16_f32 v50, v164, v172
    v_cvt_pk_bf16_f32 v51, v180, v188
    buffer_store_dwordx4 v[48:51], v1, s[44:47], s52 offen offset:0
    v_cvt_pk_bf16_f32 v52, v133, v141
    v_cvt_pk_bf16_f32 v53, v149, v157
    v_cvt_pk_bf16_f32 v54, v165, v173
    v_cvt_pk_bf16_f32 v55, v181, v189
    buffer_store_dwordx4 v[52:55], v1, s[44:47], s52 offen offset:1024
    v_cvt_pk_bf16_f32 v56, v134, v142
    v_cvt_pk_bf16_f32 v57, v150, v158
    v_cvt_pk_bf16_f32 v58, v166, v174
    v_cvt_pk_bf16_f32 v59, v182, v190
    buffer_store_dwordx4 v[56:59], v1, s[44:47], s52 offen offset:2048
    v_cvt_pk_bf16_f32 v60, v135, v143
    v_cvt_pk_bf16_f32 v61, v151, v159
    v_cvt_pk_bf16_f32 v62, v167, v175
    v_cvt_pk_bf16_f32 v63, v183, v191
    buffer_store_dwordx4 v[60:63], v1, s[44:47], s52 offen offset:3072
    s_endpgm
L_exit:
    s_endpgm
.globl gqa_reduce_kernel
.p2align 8
.type gqa_reduce_kernel,@function
gqa_reduce_kernel:
    s_cmp_ge_u32 s2, 256
    s_cbranch_scc1 L_rexit
    s_load_dwordx2 s[4:5], s[0:1], 40
    s_load_dwordx2 s[6:7], s[0:1], 56
    s_lshr_b32 s3, s2, 3
    s_and_b32 s24, s2, 7
    v_and_b32 v1, 255, v0
    v_and_b32 v2, 63, v0
    v_lshrrev_b32 v3, 6, v1
    v_lshlrev_b32 v1, 4, v1
    s_lshl_b32 s25, s3, 18
    s_lshl_b32 s26, s24, 12
    s_add_u32 s25, s25, s26
    v_add_u32 v1, s25, v1
    v_and_b32 v4, 15, v2
    v_lshlrev_b32 v4, 10, v4
    v_lshrrev_b32 v5, 4, v2
    v_lshlrev_b32 v5, 6, v5
    v_lshlrev_b32 v3, 4, v3
    v_add3_u32 v4, v4, v5, v3
    s_lshl_b32 s25, s3, 15
    s_and_b32 s26, s24, 3
    s_lshl_b32 s26, s26, 8
    s_add_u32 s25, s25, s26
    s_lshr_b32 s26, s24, 2
    s_lshl_b32 s26, s26, 14
    s_add_u32 s25, s25, s26
    v_add_u32 v4, s25, v4
    s_waitcnt lgkmcnt(0)
    s_mov_b32 s8, s4
    s_and_b32 s9, s5, 0xffff
    s_mov_b32 s10, 1048576
    s_mov_b32 s11, 0x00020000
    s_mov_b32 s12, s6
    s_and_b32 s13, s7, 0xffff
    s_mov_b32 s14, 8388608
    s_mov_b32 s15, 0x00020000
    s_mov_b32 s16, 0
    s_mov_b32 s17, 32768
    s_mov_b32 s18, 65536
    s_mov_b32 s19, 98304
    s_mov_b32 s20, 131072
    s_mov_b32 s21, 163840
    s_mov_b32 s22, 196608
    s_mov_b32 s23, 229376
    buffer_load_dwordx4 v[8:11], v1, s[12:15], s16 offen offset:0
    buffer_load_dwordx4 v[12:15], v1, s[12:15], s17 offen offset:0
    buffer_load_dwordx4 v[16:19], v1, s[12:15], s18 offen offset:0
    buffer_load_dwordx4 v[20:23], v1, s[12:15], s19 offen offset:0
    buffer_load_dwordx4 v[24:27], v1, s[12:15], s20 offen offset:0
    buffer_load_dwordx4 v[28:31], v1, s[12:15], s21 offen offset:0
    buffer_load_dwordx4 v[32:35], v1, s[12:15], s22 offen offset:0
    buffer_load_dwordx4 v[36:39], v1, s[12:15], s23 offen offset:0
    s_waitcnt vmcnt(7)
    v_lshlrev_b32 v40, 16, v8
    v_and_b32 v41, 0xffff0000, v8
    v_lshlrev_b32 v42, 16, v9
    v_and_b32 v43, 0xffff0000, v9
    v_lshlrev_b32 v44, 16, v10
    v_and_b32 v45, 0xffff0000, v10
    v_lshlrev_b32 v46, 16, v11
    v_and_b32 v47, 0xffff0000, v11
    s_waitcnt vmcnt(6)
    v_lshlrev_b32 v48, 16, v12
    v_and_b32 v49, 0xffff0000, v12
    v_add_f32 v40, v40, v48
    v_add_f32 v41, v41, v49
    v_lshlrev_b32 v48, 16, v13
    v_and_b32 v49, 0xffff0000, v13
    v_add_f32 v42, v42, v48
    v_add_f32 v43, v43, v49
    v_lshlrev_b32 v48, 16, v14
    v_and_b32 v49, 0xffff0000, v14
    v_add_f32 v44, v44, v48
    v_add_f32 v45, v45, v49
    v_lshlrev_b32 v48, 16, v15
    v_and_b32 v49, 0xffff0000, v15
    v_add_f32 v46, v46, v48
    v_add_f32 v47, v47, v49
    s_waitcnt vmcnt(5)
    v_lshlrev_b32 v48, 16, v16
    v_and_b32 v49, 0xffff0000, v16
    v_add_f32 v40, v40, v48
    v_add_f32 v41, v41, v49
    v_lshlrev_b32 v48, 16, v17
    v_and_b32 v49, 0xffff0000, v17
    v_add_f32 v42, v42, v48
    v_add_f32 v43, v43, v49
    v_lshlrev_b32 v48, 16, v18
    v_and_b32 v49, 0xffff0000, v18
    v_add_f32 v44, v44, v48
    v_add_f32 v45, v45, v49
    v_lshlrev_b32 v48, 16, v19
    v_and_b32 v49, 0xffff0000, v19
    v_add_f32 v46, v46, v48
    v_add_f32 v47, v47, v49
    s_waitcnt vmcnt(4)
    v_lshlrev_b32 v48, 16, v20
    v_and_b32 v49, 0xffff0000, v20
    v_add_f32 v40, v40, v48
    v_add_f32 v41, v41, v49
    v_lshlrev_b32 v48, 16, v21
    v_and_b32 v49, 0xffff0000, v21
    v_add_f32 v42, v42, v48
    v_add_f32 v43, v43, v49
    v_lshlrev_b32 v48, 16, v22
    v_and_b32 v49, 0xffff0000, v22
    v_add_f32 v44, v44, v48
    v_add_f32 v45, v45, v49
    v_lshlrev_b32 v48, 16, v23
    v_and_b32 v49, 0xffff0000, v23
    v_add_f32 v46, v46, v48
    v_add_f32 v47, v47, v49
    s_waitcnt vmcnt(3)
    v_lshlrev_b32 v48, 16, v24
    v_and_b32 v49, 0xffff0000, v24
    v_add_f32 v40, v40, v48
    v_add_f32 v41, v41, v49
    v_lshlrev_b32 v48, 16, v25
    v_and_b32 v49, 0xffff0000, v25
    v_add_f32 v42, v42, v48
    v_add_f32 v43, v43, v49
    v_lshlrev_b32 v48, 16, v26
    v_and_b32 v49, 0xffff0000, v26
    v_add_f32 v44, v44, v48
    v_add_f32 v45, v45, v49
    v_lshlrev_b32 v48, 16, v27
    v_and_b32 v49, 0xffff0000, v27
    v_add_f32 v46, v46, v48
    v_add_f32 v47, v47, v49
    s_waitcnt vmcnt(2)
    v_lshlrev_b32 v48, 16, v28
    v_and_b32 v49, 0xffff0000, v28
    v_add_f32 v40, v40, v48
    v_add_f32 v41, v41, v49
    v_lshlrev_b32 v48, 16, v29
    v_and_b32 v49, 0xffff0000, v29
    v_add_f32 v42, v42, v48
    v_add_f32 v43, v43, v49
    v_lshlrev_b32 v48, 16, v30
    v_and_b32 v49, 0xffff0000, v30
    v_add_f32 v44, v44, v48
    v_add_f32 v45, v45, v49
    v_lshlrev_b32 v48, 16, v31
    v_and_b32 v49, 0xffff0000, v31
    v_add_f32 v46, v46, v48
    v_add_f32 v47, v47, v49
    s_waitcnt vmcnt(1)
    v_lshlrev_b32 v48, 16, v32
    v_and_b32 v49, 0xffff0000, v32
    v_add_f32 v40, v40, v48
    v_add_f32 v41, v41, v49
    v_lshlrev_b32 v48, 16, v33
    v_and_b32 v49, 0xffff0000, v33
    v_add_f32 v42, v42, v48
    v_add_f32 v43, v43, v49
    v_lshlrev_b32 v48, 16, v34
    v_and_b32 v49, 0xffff0000, v34
    v_add_f32 v44, v44, v48
    v_add_f32 v45, v45, v49
    v_lshlrev_b32 v48, 16, v35
    v_and_b32 v49, 0xffff0000, v35
    v_add_f32 v46, v46, v48
    v_add_f32 v47, v47, v49
    s_waitcnt vmcnt(0)
    v_lshlrev_b32 v48, 16, v36
    v_and_b32 v49, 0xffff0000, v36
    v_add_f32 v40, v40, v48
    v_add_f32 v41, v41, v49
    v_lshlrev_b32 v48, 16, v37
    v_and_b32 v49, 0xffff0000, v37
    v_add_f32 v42, v42, v48
    v_add_f32 v43, v43, v49
    v_lshlrev_b32 v48, 16, v38
    v_and_b32 v49, 0xffff0000, v38
    v_add_f32 v44, v44, v48
    v_add_f32 v45, v45, v49
    v_lshlrev_b32 v48, 16, v39
    v_and_b32 v49, 0xffff0000, v39
    v_add_f32 v46, v46, v48
    v_add_f32 v47, v47, v49
    v_cvt_pk_bf16_f32 v50, v40, v41
    v_cvt_pk_bf16_f32 v51, v42, v43
    v_cvt_pk_bf16_f32 v52, v44, v45
    v_cvt_pk_bf16_f32 v53, v46, v47
    buffer_store_dwordx4 v[50:53], v4, s[8:11], 0 offen offset:0
L_rexit:
    s_endpgm
.section .rodata,"a"
.p2align 6
.amdhsa_kernel standalone__gqa_block_cached__near_ridge_kernel
  .amdhsa_next_free_vgpr 256
  .amdhsa_next_free_sgpr 102
  .amdhsa_accum_offset 256
  .amdhsa_group_segment_fixed_size 0
  .amdhsa_kernarg_size 64
  .amdhsa_user_sgpr_count 2
  .amdhsa_user_sgpr_kernarg_segment_ptr 1
  .amdhsa_system_sgpr_workgroup_id_x 1
.end_amdhsa_kernel
.p2align 6
.amdhsa_kernel gqa_reduce_kernel
  .amdhsa_next_free_vgpr 56
  .amdhsa_next_free_sgpr 102
  .amdhsa_accum_offset 56
  .amdhsa_group_segment_fixed_size 0
  .amdhsa_kernarg_size 64
  .amdhsa_user_sgpr_count 2
  .amdhsa_user_sgpr_kernarg_segment_ptr 1
  .amdhsa_system_sgpr_workgroup_id_x 1
.end_amdhsa_kernel
```
